```python
import torch

def _softmax(x, axis=-1):
    return torch.softmax(x, dim=axis)
def _gelu(x):
    return torch.nn.functional.gelu(x, approximate="tanh")
def _silu(x):
    return torch.nn.functional.silu(x)
def _sigmoid(x):
    return torch.sigmoid(x)
def _layernorm(x, axis=-1, eps=1e-5):
    m = x.mean(dim=axis, keepdim=True)
    v = x.var(dim=axis, keepdim=True, unbiased=False)
    return (x - m) / torch.sqrt(v + eps)
def _scatter_add(tgt, idx, src, axis=0):
    return tgt.clone().index_add_(axis, idx, src)
def _segment_sum(src, seg, n):
    out = torch.zeros((n,) + src.shape[1:], dtype=src.dtype)
    return out.index_add_(0, seg, src)
def _pad(x, pw):
    flat = tuple(v for pair in reversed(pw) for v in pair)
    return torch.nn.functional.pad(x, flat)

kernel_name = 'parallel_sum__softmax_full_mha__glu_gated_swiglu__prompt'

def setup_inputs():

    _w = (lambda a: (lambda t: t.to(torch.bfloat16) if t.is_floating_point() else t)(torch.as_tensor(a)))
    def _A_setup():
        B, S, D = 1, 2048, 512
        return {
            "x": _w((lambda *s: torch.randn(*s, dtype=torch.bfloat16) * 0.05)(B, S, D)),
            "wqkv": _w((lambda *s: torch.randn(*s, dtype=torch.bfloat16) * 0.05)(D, 3 * D)),
            "wo": _w((lambda *s: torch.randn(*s, dtype=torch.bfloat16) * 0.05)(D, D)),
        }
    _A_in = _A_setup()

    def _B_setup():
        B, S, D, F = 1, 2048, 512, 1792
        return {
            "x": _w((lambda *s: torch.randn(*s, dtype=torch.bfloat16) * 0.05)(B, S, D)),
            "w1": _w((lambda *s: torch.randn(*s, dtype=torch.bfloat16) * 0.4)(D, F) * (2.0 / D) ** 0.5),
            "w3": _w((lambda *s: torch.randn(*s, dtype=torch.bfloat16) * 0.4)(D, F) * (2.0 / D) ** 0.5),
            "w2": _w((lambda *s: torch.randn(*s, dtype=torch.bfloat16) * 0.4)(F, D) * (2.0 / F) ** 0.5),
        }
    _B_in = _B_setup()

    return {
        "A_x": _A_in["x"],
        "A_wqkv": _A_in["wqkv"],
        "A_wo": _A_in["wo"],
        "B_x": _B_in["x"],
        "B_w1": _B_in["w1"],
        "B_w3": _B_in["w3"],
        "B_w2": _B_in["w2"],
    }

def reference(A_x, A_wqkv, A_wo, B_x, B_w1, B_w3, B_w2):
    def _A_ref(x, wqkv, wo):
        B, S, D = x.shape
        H = 32; Dh = D // H
        qkv = (lambda x, *d: x.permute(*d))((x @ wqkv).reshape(B, S, 3, H, Dh), 2, 0, 3, 1, 4)
        q, k, v = qkv[0], qkv[1], qkv[2]
        scale = Dh ** -0.5
        scores = torch.einsum("bhqd,bhkd->bhqk", q, k) * scale
        p = _softmax(scores, axis=-1)
        o = torch.einsum("bhqk,bhkd->bhqd", p, v)
        return (lambda x, *d: x.permute(*d))(o, 0, 2, 1, 3).reshape(B, S, D) @ wo

    def _B_ref(x, w1, w3, w2):
        gate = torch.einsum("bsd,df->bsf", x, w1)
        up = torch.einsum("bsd,df->bsf", x, w3)
        h = _silu(gate) * up
        out = torch.einsum("bsf,fd->bsd", h, w2)
        return out

    x = A_x
    xn = _layernorm(x, axis=-1)
    return x + _A_ref(xn, A_wqkv, A_wo) + _B_ref(xn, B_w1, B_w3, B_w2)
```

```asm
; @launch grid=(256,1,1) block=(512,1,1) lds=163840
.amdgcn_target "amdgcn-amd-amdhsa--gfx950"
.text
.globl parallel_sum__softmax_full_mha__glu_gated_swiglu__prompt_kernel
.p2align 8
.type parallel_sum__softmax_full_mha__glu_gated_swiglu__prompt_kernel,@function
parallel_sum__softmax_full_mha__glu_gated_swiglu__prompt_kernel:
    s_cmp_ge_u32 s2, 256
    s_cbranch_scc1 L_END
    s_load_dwordx16 s[4:19], s[0:1], 0
    s_load_dwordx4 s[20:23], s[0:1], 64
    s_getpc_b64 s[64:65]
L_PC:
    v_lshlrev_b32 v2, 6, v0
    v_min_u32 v2, 28788, v2
    global_load_dword v255, v2, s[64:65]
    v_lshrrev_b32 v1, 6, v0
    v_and_b32 v17, 63, v0
    v_readfirstlane_b32 s56, v1
    s_and_b32 s61, s2, 7
    s_lshr_b32 s62, s2, 3
    s_and_b32 s63, s61, 1
    s_lshl_b32 s63, s63, 3
    s_and_b32 s64, s62, 7
    s_add_u32 s57, s63, s64
    s_lshr_b32 s63, s61, 1
    s_lshr_b32 s64, s62, 3
    s_lshl_b32 s64, s64, 2
    s_add_u32 s58, s63, s64
    s_lshl_b32 s63, s61, 2
    s_and_b32 s64, s62, 3
    s_add_u32 s59, s63, s64
    s_lshr_b32 s60, s2, 5
    s_cmp_lt_u32 s56, 4
    s_cbranch_scc1 L_COMPUTE
    s_sub_u32 s61, s56, 4
    s_lshr_b32 s62, s58, 2
    s_lshl_b32 s62, s62, 1
    s_add_u32 s62, s62, s57
    s_and_b32 s63, s58, 1
    s_add_u32 s62, s62, s63
    s_and_b32 s62, s62, 7
    s_lshl_b32 s92, s62, 7
    v_lshrrev_b32 v2, 3, v17
    v_and_b32 v3, 7, v17
    s_lshl_b32 s63, s57, 7
    s_lshl_b32 s64, s61, 5
    s_add_u32 s63, s63, s64
    s_lshl_b32 s63, s63, 10
    v_lshrrev_b32 v4, 1, v2
    v_xor_b32 v4, v4, v3
    v_lshlrev_b32 v4, 4, v4
    v_lshl_add_u32 v4, v2, 10, v4
    v_add_u32 v5, s63, v4
    v_xor_b32 v6, 64, v5
    v_add_u32 v6, 0x2000, v6
    v_add_u32 v7, 0x4000, v5
    v_add_u32 v8, 0x4000, v6
    s_lshl_b32 s91, s61, 12
    s_waitcnt lgkmcnt(0)
    s_mov_b32 s28, s4
    s_mov_b32 s29, s5
    s_mov_b32 s30, 2097152
    s_mov_b32 s31, 0x00020000
    s_add_u32 m0, s91, 40960
    s_nop 0
    buffer_load_dwordx4 v5, s[28:31], s92 offen lds
    s_add_u32 m0, s91, 41984
    s_nop 0
    buffer_load_dwordx4 v6, s[28:31], s92 offen lds
    s_add_u32 m0, s91, 43008
    s_nop 0
    buffer_load_dwordx4 v7, s[28:31], s92 offen lds
    s_add_u32 m0, s91, 44032
    s_nop 0
    buffer_load_dwordx4 v8, s[28:31], s92 offen lds
    s_add_u32 s92, s92, 128
    s_and_b32 s92, s92, 1023
    s_mov_b32 s40, s6
    s_mov_b32 s41, s7
    s_mov_b32 s42, 1572864
    s_mov_b32 s43, 0x00020000
    s_mov_b32 s44, s12
    s_mov_b32 s45, s13
    s_mov_b32 s46, 1835008
    s_mov_b32 s47, 0x00020000
    s_mov_b32 s48, s14
    s_mov_b32 s49, s15
    s_mov_b32 s50, 1835008
    s_mov_b32 s51, 0x00020000
    v_bfe_u32 v4, v2, 1, 1
    v_lshlrev_b32 v4, 2, v4
    v_xor_b32 v4, v4, v3
    v_lshlrev_b32 v4, 4, v4
    s_lshl_b32 s63, s61, 4
    v_add_u32 v9, s63, v2
    v_mul_u32_u24 v15, 3072, v9
    v_add_u32 v15, v15, v4
    s_lshl_b32 s63, s58, 7
    s_add_u32 s63, s63, 1024
    v_add_u32 v10, s63, v15
    v_add_u32 v11, 24576, v10
    v_xor_b32 v11, 16, v11
    s_mul_i32 s80, s62, 196608
    s_mul_i32 s82, s62, 229376
    s_add_u32 s10, s62, 5
    s_and_b32 s10, s10, 7
    s_mul_i32 s10, s10, 229376
    s_mul_i32 s90, s61, 6144
    s_add_u32 s90, s90, 16384
    s_add_u32 m0, s90, 45056
    s_nop 0
    buffer_load_dwordx4 v10, s[40:43], s80 offen lds
    s_add_u32 m0, s90, 46080
    s_nop 0
    buffer_load_dwordx4 v11, s[40:43], s80 offen lds
    v_mul_u32_u24 v16, 3584, v9
    v_add_u32 v16, v16, v4
    s_add_u32 s63, s58, 16
    s_lshl_b32 s63, s63, 7
    s_sub_u32 s64, s58, 12
    s_lshl_b32 s64, s64, 8
    s_add_u32 s65, s64, 128
    s_cmp_lt_u32 s58, 12
    s_cselect_b64 vcc, -1, 0
    s_cselect_b32 s32, s12, s6
    s_cselect_b32 s33, s13, s7
    s_cselect_b32 s34, s46, s42
    s_cselect_b32 s36, s14, s6
    s_cselect_b32 s37, s15, s7
    s_cselect_b32 s38, s46, s42
    s_cselect_b32 s64, s63, s64
    s_cselect_b32 s65, s63, s65
    s_cselect_b32 s81, s82, s80
    s_cselect_b32 s66, 7, 6
    s_mov_b32 s35, 0x00020000
    s_mov_b32 s39, 0x00020000
    s_lshl_b32 s83, s66, 15
    s_lshl_b32 s66, s66, 12
    v_cndmask_b32 v15, v15, v16, vcc
    v_add_u32 v12, s64, v15
    v_add_u32 v13, s66, v12
    v_add_u32 v14, s65, v15
    v_add_u32 v15, s66, v14
    v_xor_b32 v13, 16, v13
    v_xor_b32 v15, 16, v15
    s_add_u32 m0, s90, 40960
    s_nop 0
    buffer_load_dwordx4 v12, s[32:35], s81 offen lds
    s_add_u32 m0, s90, 41984
    s_nop 0
    buffer_load_dwordx4 v13, s[32:35], s81 offen lds
    s_add_u32 m0, s90, 43008
    s_nop 0
    buffer_load_dwordx4 v14, s[36:39], s81 offen lds
    s_add_u32 m0, s90, 44032
    s_nop 0
    buffer_load_dwordx4 v15, s[36:39], s81 offen lds
    s_add_u32 s80, s80, 196608
    s_cmp_ge_u32 s80, s42
    s_cselect_b32 s80, 0, s80
    s_add_u32 s81, s81, s83
    s_cmp_ge_u32 s81, s34
    s_cselect_b32 s81, 0, s81
    s_lshl_b32 s63, s58, 7
    v_add_u32 v20, s63, v16
    v_add_u32 v21, 28672, v20
    v_xor_b32 v21, 16, v21
    v_mov_b32 v22, v20
    v_mov_b32 v23, v21
    s_add_u32 m0, s91, 81920
    s_nop 0
    buffer_load_dwordx4 v5, s[28:31], s92 offen lds
    s_add_u32 m0, s91, 82944
    s_nop 0
    buffer_load_dwordx4 v6, s[28:31], s92 offen lds
    s_add_u32 m0, s91, 83968
    s_nop 0
    buffer_load_dwordx4 v7, s[28:31], s92 offen lds
    s_add_u32 m0, s91, 84992
    s_nop 0
    buffer_load_dwordx4 v8, s[28:31], s92 offen lds
    s_add_u32 s92, s92, 128
    s_and_b32 s92, s92, 1023
    s_add_u32 m0, s90, 86016
    s_nop 0
    buffer_load_dwordx4 v10, s[40:43], s80 offen lds
    s_add_u32 m0, s90, 87040
    s_nop 0
    buffer_load_dwordx4 v11, s[40:43], s80 offen lds
    s_add_u32 m0, s90, 81920
    s_nop 0
    buffer_load_dwordx4 v12, s[32:35], s81 offen lds
    s_add_u32 m0, s90, 82944
    s_nop 0
    buffer_load_dwordx4 v13, s[32:35], s81 offen lds
    s_add_u32 m0, s90, 83968
    s_nop 0
    buffer_load_dwordx4 v14, s[36:39], s81 offen lds
    s_add_u32 m0, s90, 84992
    s_nop 0
    buffer_load_dwordx4 v15, s[36:39], s81 offen lds
    s_add_u32 s80, s80, 196608
    s_cmp_ge_u32 s80, s42
    s_cselect_b32 s80, 0, s80
    s_add_u32 s81, s81, s83
    s_cmp_ge_u32 s81, s34
    s_cselect_b32 s81, 0, s81
    s_mov_b32 s24, s22
    s_mov_b32 s25, s23
    s_mov_b32 s26, 19922944
    s_mov_b32 s27, 0x00020000
    s_cmp_lt_u32 s2, 112
    s_cselect_b32 s52, s16, s8
    s_cselect_b32 s53, s17, s9
    s_cselect_b32 s54, 7, 2
    s_cselect_b32 s86, 0, 112
    s_mov_b32 s55, 0x00020000
    s_lshl_b32 s54, s54, 18
    s_sub_u32 s86, s2, s86
    s_lshl_b32 s86, s86, 14
    s_lshl_b32 s63, s61, 8
    s_add_u32 s86, s86, s63
    v_lshl_add_u32 v18, v2, 10, v4
    v_lshrrev_b32 v19, 5, v17
    v_bfe_u32 v24, v17, 2, 2
    v_lshl_add_u32 v24, v19, 2, v24
    v_lshlrev_b32 v24, 7, v24
    v_bfe_u32 v19, v17, 4, 1
    v_bfe_u32 v25, v17, 3, 1
    v_lshl_or_b32 v19, v25, 1, v19
    v_lshl_add_u32 v24, v19, 5, v24
    v_and_b32 v19, 3, v17
    v_lshl_add_u32 v24, v19, 3, v24
    s_add_u32 s89, s91, 135168
    v_add_u32 v24, s89, v24
    v_xor_b32 v25, 64, v24
    v_lshlrev_b32 v2, 4, v17
    s_mul_i32 s87, s61, 576
    s_add_u32 s87, s87, s2
    s_lshl_b32 s87, s87, 10
    s_add_u32 s87, s87, 15728640
    s_cmp_lt_u32 s2, 144
    s_cselect_b32 s87, s87, 19922944
    s_lshr_b32 s64, s59, 2
    s_add_u32 s65, s64, 8
    s_lshr_b32 s66, s59, 3
    s_add_u32 s66, s66, 12
    v_and_b32 v3, 15, v17
    v_and_b32 v4, 1, v17
    s_lshl_b32 s67, s60, 1
    v_add_u32 v26, s67, v4
    v_cmp_gt_u32 vcc, 32, v17
    v_mov_b32 v27, s66
    v_mov_b32 v28, s65
    v_cndmask_b32 v29, v26, v3, vcc
    v_cndmask_b32 v27, v27, v28, vcc
    v_cmp_gt_u32 vcc, 16, v17
    v_mov_b32 v28, s64
    s_nop 0
    v_cndmask_b32 v27, v27, v28, vcc
    v_lshl_add_u32 v3, v29, 4, v27
    v_lshlrev_b32 v3, 7, v3
    s_lshl_b32 s67, s2, 7
    s_lshl_b32 s63, s61, 2
    s_add_u32 s67, s67, s63
    s_add_u32 s67, s67, 18907136
    s_mov_b32 s68, 0
    s_mov_b32 s69, 19038208
    s_lshl_b32 s63, s59, 17
    s_add_u32 s63, s63, 2097152
    s_lshl_b32 s64, s61, 10
    s_add_u32 s63, s63, s64
    s_lshr_b32 s64, s61, 1
    s_mul_i32 s64, s64, 2080
    s_and_b32 s65, s61, 1
    s_lshl_b32 s65, s65, 10
    s_add_u32 s64, s64, s65
    s_lshl_b32 s65, s59, 6
    s_lshl_b32 s66, s60, 3
    s_add_u32 s65, s65, s66
    s_lshl_b32 s66, s61, 1
    s_add_u32 s65, s65, s66
    s_lshl_b32 s65, s65, 10
    s_lshl_b32 s66, s61, 11
    s_mov_b32 s96, s20
    s_mov_b32 s97, s21
    s_mov_b32 s98, 256
    s_mov_b32 s99, 0x00020000
    v_and_b32 v28, 7, v17
    s_and_b32 s84, s61, 1
    s_lshl_b32 s84, s84, 3
    v_add_u32 v28, s84, v28
    s_lshl_b32 s84, s61, 5
    v_add_u32 v4, s84, v4
    v_lshl_add_u32 v27, v28, 4, s58
    s_lshl_b32 s84, s57, 4
    v_add_u32 v26, s84, v28
    v_cmp_gt_u32 vcc, 16, v17
    v_lshlrev_b32 v4, 7, v4
    s_nop 0
    v_cndmask_b32 v26, v26, v27, vcc
    v_lshlrev_b32 v26, 7, v26
    v_lshlrev_b32 v27, 7, v27
    s_mul_i32 s84, s58, 20480
    s_add_u32 s84, s84, 19398656
    s_lshl_b32 s85, s61, 10
    s_add_u32 s84, s84, s85
    s_mov_b32 s88, 18972672
    s_waitcnt vmcnt(10)
    s_barrier
    s_add_u32 m0, s91, 0
    s_nop 0
    buffer_load_dwordx4 v5, s[28:31], s92 offen lds
    s_add_u32 m0, s91, 1024
    s_nop 0
    buffer_load_dwordx4 v6, s[28:31], s92 offen lds
    s_add_u32 m0, s91, 2048
    s_nop 0
    buffer_load_dwordx4 v7, s[28:31], s92 offen lds
    s_add_u32 m0, s91, 3072
    s_nop 0
    buffer_load_dwordx4 v8, s[28:31], s92 offen lds
    s_add_u32 s92, s92, 128
    s_and_b32 s92, s92, 1023
    s_add_u32 m0, s90, 4096
    s_nop 0
    buffer_load_dwordx4 v10, s[40:43], s80 offen lds
    s_add_u32 m0, s90, 5120
    s_nop 0
    buffer_load_dwordx4 v11, s[40:43], s80 offen lds
    s_add_u32 m0, s90, 0
    s_nop 0
    buffer_load_dwordx4 v12, s[32:35], s81 offen lds
    s_add_u32 m0, s90, 1024
    s_nop 0
    buffer_load_dwordx4 v13, s[32:35], s81 offen lds
    s_add_u32 m0, s90, 2048
    s_nop 0
    buffer_load_dwordx4 v14, s[36:39], s81 offen lds
    s_add_u32 m0, s90, 3072
    s_nop 0
    buffer_load_dwordx4 v15, s[36:39], s81 offen lds
    s_add_u32 s80, s80, 196608
    s_cmp_ge_u32 s80, s42
    s_cselect_b32 s80, 0, s80
    s_add_u32 s81, s81, s83
    s_cmp_ge_u32 s81, s34
    s_cselect_b32 s81, 0, s81
    s_waitcnt vmcnt(10)
    s_barrier
    s_add_u32 m0, s91, 40960
    s_nop 0
    buffer_load_dwordx4 v5, s[28:31], s92 offen lds
    s_add_u32 m0, s91, 41984
    s_nop 0
    buffer_load_dwordx4 v6, s[28:31], s92 offen lds
    s_add_u32 m0, s91, 43008
    s_nop 0
    buffer_load_dwordx4 v7, s[28:31], s92 offen lds
    s_add_u32 m0, s91, 44032
    s_nop 0
    buffer_load_dwordx4 v8, s[28:31], s92 offen lds
    s_add_u32 s92, s92, 128
    s_and_b32 s92, s92, 1023
    s_add_u32 m0, s90, 45056
    s_nop 0
    buffer_load_dwordx4 v10, s[40:43], s80 offen lds
    s_add_u32 m0, s90, 46080
    s_nop 0
    buffer_load_dwordx4 v11, s[40:43], s80 offen lds
    s_add_u32 m0, s90, 40960
    s_nop 0
    buffer_load_dwordx4 v12, s[32:35], s81 offen lds
    s_add_u32 m0, s90, 41984
    s_nop 0
    buffer_load_dwordx4 v13, s[32:35], s81 offen lds
    s_add_u32 m0, s90, 43008
    s_nop 0
    buffer_load_dwordx4 v14, s[36:39], s81 offen lds
    s_add_u32 m0, s90, 44032
    s_nop 0
    buffer_load_dwordx4 v15, s[36:39], s81 offen lds
    s_add_u32 s80, s80, 196608
    s_cmp_ge_u32 s80, s42
    s_cselect_b32 s80, 0, s80
    s_add_u32 s81, s81, s83
    s_cmp_ge_u32 s81, s34
    s_cselect_b32 s81, 0, s81
    s_waitcnt vmcnt(10)
    s_barrier
    s_add_u32 m0, s91, 81920
    s_nop 0
    buffer_load_dwordx4 v5, s[28:31], s92 offen lds
    s_add_u32 m0, s91, 82944
    s_nop 0
    buffer_load_dwordx4 v6, s[28:31], s92 offen lds
    s_add_u32 m0, s91, 83968
    s_nop 0
    buffer_load_dwordx4 v7, s[28:31], s92 offen lds
    s_add_u32 m0, s91, 84992
    s_nop 0
    buffer_load_dwordx4 v8, s[28:31], s92 offen lds
    s_add_u32 s92, s92, 128
    s_and_b32 s92, s92, 1023
    s_add_u32 m0, s90, 86016
    s_nop 0
    buffer_load_dwordx4 v10, s[40:43], s80 offen lds
    s_add_u32 m0, s90, 87040
    s_nop 0
    buffer_load_dwordx4 v11, s[40:43], s80 offen lds
    s_add_u32 m0, s90, 81920
    s_nop 0
    buffer_load_dwordx4 v12, s[32:35], s81 offen lds
    s_add_u32 m0, s90, 82944
    s_nop 0
    buffer_load_dwordx4 v13, s[32:35], s81 offen lds
    s_add_u32 m0, s90, 83968
    s_nop 0
    buffer_load_dwordx4 v14, s[36:39], s81 offen lds
    s_add_u32 m0, s90, 84992
    s_nop 0
    buffer_load_dwordx4 v15, s[36:39], s81 offen lds
    s_add_u32 s80, s80, 196608
    s_cmp_ge_u32 s80, s42
    s_cselect_b32 s80, 0, s80
    s_add_u32 s81, s81, s83
    s_cmp_ge_u32 s81, s34
    s_cselect_b32 s81, 0, s81
    s_add_u32 m0, s91, 139264
    s_nop 0
    buffer_load_dwordx4 v20, s[44:47], s82 offen lds
    s_add_u32 m0, s91, 140288
    s_nop 0
    buffer_load_dwordx4 v21, s[44:47], s82 offen lds
    s_add_u32 m0, s91, 141312
    s_nop 0
    buffer_load_dwordx4 v22, s[48:51], s82 offen lds
    s_add_u32 m0, s91, 142336
    s_nop 0
    buffer_load_dwordx4 v23, s[48:51], s82 offen lds
    s_add_u32 s82, s82, 229376
    s_cmp_ge_u32 s82, s46
    s_cselect_b32 s82, 0, s82
    s_waitcnt vmcnt(14)
    s_barrier
    s_add_u32 m0, s91, 0
    s_nop 0
    buffer_load_dwordx4 v5, s[28:31], s92 offen lds
    s_add_u32 m0, s91, 1024
    s_nop 0
    buffer_load_dwordx4 v6, s[28:31], s92 offen lds
    s_add_u32 m0, s91, 2048
    s_nop 0
    buffer_load_dwordx4 v7, s[28:31], s92 offen lds
    s_add_u32 m0, s91, 3072
    s_nop 0
    buffer_load_dwordx4 v8, s[28:31], s92 offen lds
    s_add_u32 s92, s92, 128
    s_and_b32 s92, s92, 1023
    s_add_u32 m0, s90, 4096
    s_nop 0
    buffer_load_dwordx4 v10, s[40:43], s80 offen lds
    s_add_u32 m0, s90, 5120
    s_nop 0
    buffer_load_dwordx4 v11, s[40:43], s80 offen lds
    s_add_u32 m0, s90, 0
    s_nop 0
    buffer_load_dwordx4 v12, s[32:35], s81 offen lds
    s_add_u32 m0, s90, 1024
    s_nop 0
    buffer_load_dwordx4 v13, s[32:35], s81 offen lds
    s_add_u32 m0, s90, 2048
    s_nop 0
    buffer_load_dwordx4 v14, s[36:39], s81 offen lds
    s_add_u32 m0, s90, 3072
    s_nop 0
    buffer_load_dwordx4 v15, s[36:39], s81 offen lds
    s_add_u32 s80, s80, 196608
    s_cmp_ge_u32 s80, s42
    s_cselect_b32 s80, 0, s80
    s_add_u32 s81, s81, s83
    s_cmp_ge_u32 s81, s34
    s_cselect_b32 s81, 0, s81
    buffer_load_dword v44, v4, s[96:99], 0 offen sc1
    s_waitcnt vmcnt(15)
    s_barrier
    s_add_u32 m0, s91, 40960
    s_nop 0
    buffer_load_dwordx4 v5, s[28:31], s92 offen lds
    s_add_u32 m0, s91, 41984
    s_nop 0
    buffer_load_dwordx4 v6, s[28:31], s92 offen lds
    s_add_u32 m0, s91, 43008
    s_nop 0
    buffer_load_dwordx4 v7, s[28:31], s92 offen lds
    s_add_u32 m0, s91, 44032
    s_nop 0
    buffer_load_dwordx4 v8, s[28:31], s92 offen lds
    s_add_u32 s92, s92, 128
    s_and_b32 s92, s92, 1023
    s_add_u32 m0, s90, 45056
    s_nop 0
    buffer_load_dwordx4 v10, s[40:43], s80 offen lds
    s_add_u32 m0, s90, 46080
    s_nop 0
    buffer_load_dwordx4 v11, s[40:43], s80 offen lds
    s_add_u32 m0, s90, 40960
    s_nop 0
    buffer_load_dwordx4 v12, s[32:35], s81 offen lds
    s_add_u32 m0, s90, 41984
    s_nop 0
    buffer_load_dwordx4 v13, s[32:35], s81 offen lds
    s_add_u32 m0, s90, 43008
    s_nop 0
    buffer_load_dwordx4 v14, s[36:39], s81 offen lds
    s_add_u32 m0, s90, 44032
    s_nop 0
    buffer_load_dwordx4 v15, s[36:39], s81 offen lds
    s_add_u32 s80, s80, 196608
    s_cmp_ge_u32 s80, s42
    s_cselect_b32 s80, 0, s80
    s_add_u32 s81, s81, s83
    s_cmp_ge_u32 s81, s34
    s_cselect_b32 s81, 0, s81
    s_cmp_lg_u32 s61, 0
    s_cbranch_scc1 L_POLL0X
    s_waitcnt vmcnt(10)
    v_cmp_gt_u32 vcc, 128, v44
    s_cbranch_vccz L_POLL0X
L_POLL0:
    buffer_load_dword v44, v4, s[96:99], 0 offen sc1
    s_add_u32 s68, s68, 1
    s_waitcnt vmcnt(0)
    v_cmp_gt_u32 vcc, 128, v44
    s_cmp_gt_u32 s68, 131072
    s_cbranch_scc1 L_POLL0X
    s_cbranch_vccz L_POLL0X
    s_sleep 8
    s_branch L_POLL0
L_POLL0X:
    s_waitcnt vmcnt(11)
    s_barrier
    s_add_u32 m0, s91, 81920
    s_nop 0
    buffer_load_dwordx4 v5, s[28:31], s92 offen lds
    s_add_u32 m0, s91, 82944
    s_nop 0
    buffer_load_dwordx4 v6, s[28:31], s92 offen lds
    s_add_u32 m0, s91, 83968
    s_nop 0
    buffer_load_dwordx4 v7, s[28:31], s92 offen lds
    s_add_u32 m0, s91, 84992
    s_nop 0
    buffer_load_dwordx4 v8, s[28:31], s92 offen lds
    s_add_u32 s92, s92, 128
    s_and_b32 s92, s92, 1023
    s_add_u32 m0, s90, 86016
    s_nop 0
    buffer_load_dwordx4 v10, s[40:43], s80 offen lds
    s_add_u32 m0, s90, 87040
    s_nop 0
    buffer_load_dwordx4 v11, s[40:43], s80 offen lds
    s_add_u32 m0, s90, 81920
    s_nop 0
    buffer_load_dwordx4 v12, s[32:35], s81 offen lds
    s_add_u32 m0, s90, 82944
    s_nop 0
    buffer_load_dwordx4 v13, s[32:35], s81 offen lds
    s_add_u32 m0, s90, 83968
    s_nop 0
    buffer_load_dwordx4 v14, s[36:39], s81 offen lds
    s_add_u32 m0, s90, 84992
    s_nop 0
    buffer_load_dwordx4 v15, s[36:39], s81 offen lds
    s_add_u32 s80, s80, 196608
    s_cmp_ge_u32 s80, s42
    s_cselect_b32 s80, 0, s80
    s_add_u32 s81, s81, s83
    s_cmp_ge_u32 s81, s34
    s_cselect_b32 s81, 0, s81
    buffer_load_dword v44, v26, s[24:27], s88 offen sc1
    s_waitcnt vmcnt(11)
    s_barrier
    s_waitcnt vmcnt(0)
    v_cmp_gt_u32 vcc, 4, v44
    s_cbranch_vccz L_POLLSX
L_POLLS:
    buffer_load_dword v44, v26, s[24:27], s88 offen sc1
    s_add_u32 s68, s68, 1
    s_waitcnt vmcnt(0)
    v_cmp_gt_u32 vcc, 4, v44
    s_cmp_gt_u32 s68, 131072
    s_cbranch_scc1 L_POLLSX
    s_cbranch_vccz L_POLLSX
    s_sleep 8
    s_branch L_POLLS
L_POLLSX:
    s_add_u32 m0, s85, 32768
    s_nop 0
    buffer_load_dwordx4 v2, s[24:27], s84 offen sc1 lds
    s_add_u32 s84, s84, 4096
    s_add_u32 m0, s85, 36864
    s_nop 0
    buffer_load_dwordx4 v2, s[24:27], s84 offen sc1 lds
    s_add_u32 s84, s84, 4096
    s_add_u32 m0, s85, 157696
    s_nop 0
    buffer_load_dwordx4 v2, s[24:27], s84 offen sc1 lds
    s_add_u32 s84, s84, 4096
    s_and_b32 s62, s61, 1
    s_lshl_b32 s62, s62, 10
    s_add_u32 m0, s62, 155648
    s_lshl_b32 s88, s57, 11
    s_add_u32 s62, s62, s88
    s_add_u32 s62, s62, 19857408
    buffer_load_dwordx4 v2, s[24:27], s62 offen sc1 lds
    s_mov_b32 s88, 19005440
    s_add_u32 m0, s91, 16384
    s_nop 0
    buffer_load_dwordx4 v20, s[44:47], s10 offen lds
    s_add_u32 m0, s91, 17408
    s_nop 0
    buffer_load_dwordx4 v21, s[44:47], s10 offen lds
    s_add_u32 m0, s91, 18432
    s_nop 0
    buffer_load_dwordx4 v22, s[48:51], s10 offen lds
    s_add_u32 m0, s91, 19456
    s_nop 0
    buffer_load_dwordx4 v23, s[48:51], s10 offen lds
    s_add_u32 s10, s10, 229376
    s_cmp_ge_u32 s10, s46
    s_cselect_b32 s10, 0, s10
    s_waitcnt vmcnt(4)
    s_barrier
    s_add_u32 m0, s91, 57344
    s_nop 0
    buffer_load_dwordx4 v20, s[44:47], s10 offen lds
    s_add_u32 m0, s91, 58368
    s_nop 0
    buffer_load_dwordx4 v21, s[44:47], s10 offen lds
    s_add_u32 m0, s91, 59392
    s_nop 0
    buffer_load_dwordx4 v22, s[48:51], s10 offen lds
    s_add_u32 m0, s91, 60416
    s_nop 0
    buffer_load_dwordx4 v23, s[48:51], s10 offen lds
    s_add_u32 s10, s10, 229376
    s_cmp_ge_u32 s10, s46
    s_cselect_b32 s10, 0, s10
    s_add_u32 m0, s91, 122880
    s_nop 0
    buffer_load_dwordx4 v5, s[28:31], s92 offen lds
    s_add_u32 m0, s91, 123904
    s_nop 0
    buffer_load_dwordx4 v6, s[28:31], s92 offen lds
    s_add_u32 m0, s91, 124928
    s_nop 0
    buffer_load_dwordx4 v7, s[28:31], s92 offen lds
    s_add_u32 m0, s91, 125952
    s_nop 0
    buffer_load_dwordx4 v8, s[28:31], s92 offen lds
    s_add_u32 s92, s92, 128
    s_and_b32 s92, s92, 1023
    s_barrier
    s_add_u32 m0, s91, 98304
    s_nop 0
    buffer_load_dwordx4 v20, s[44:47], s10 offen lds
    s_add_u32 m0, s91, 99328
    s_nop 0
    buffer_load_dwordx4 v21, s[44:47], s10 offen lds
    s_add_u32 m0, s91, 100352
    s_nop 0
    buffer_load_dwordx4 v22, s[48:51], s10 offen lds
    s_add_u32 m0, s91, 101376
    s_nop 0
    buffer_load_dwordx4 v23, s[48:51], s10 offen lds
    s_add_u32 s10, s10, 229376
    s_cmp_ge_u32 s10, s46
    s_cselect_b32 s10, 0, s10
    s_waitcnt vmcnt(12)
    s_barrier
    s_waitcnt vmcnt(8)
    s_barrier
    s_add_u32 m0, s91, 0
    s_nop 0
    buffer_load_dwordx4 v5, s[28:31], s92 offen lds
    s_add_u32 m0, s91, 1024
    s_nop 0
    buffer_load_dwordx4 v6, s[28:31], s92 offen lds
    s_add_u32 m0, s91, 2048
    s_nop 0
    buffer_load_dwordx4 v7, s[28:31], s92 offen lds
    s_add_u32 m0, s91, 3072
    s_nop 0
    buffer_load_dwordx4 v8, s[28:31], s92 offen lds
    s_add_u32 s92, s92, 128
    s_and_b32 s92, s92, 1023
    s_add_u32 m0, s91, 16384
    s_nop 0
    buffer_load_dwordx4 v20, s[44:47], s82 offen lds
    s_add_u32 m0, s91, 17408
    s_nop 0
    buffer_load_dwordx4 v21, s[44:47], s82 offen lds
    s_add_u32 m0, s91, 18432
    s_nop 0
    buffer_load_dwordx4 v22, s[48:51], s82 offen lds
    buffer_load_dword v44, v27, s[24:27], s88 offen sc1
    s_waitcnt vmcnt(8)
    s_barrier
    s_add_u32 m0, s91, 19456
    s_nop 0
    buffer_load_dwordx4 v23, s[48:51], s82 offen lds
    s_add_u32 s82, s82, 229376
    s_cmp_ge_u32 s82, s46
    s_cselect_b32 s82, 0, s82
    s_add_u32 m0, s91, 40960
    s_nop 0
    buffer_load_dwordx4 v5, s[28:31], s92 offen lds
    s_add_u32 m0, s91, 41984
    s_nop 0
    buffer_load_dwordx4 v6, s[28:31], s92 offen lds
    s_add_u32 m0, s91, 43008
    s_nop 0
    buffer_load_dwordx4 v7, s[28:31], s92 offen lds
    s_add_u32 m0, s91, 44032
    s_nop 0
    buffer_load_dwordx4 v8, s[28:31], s92 offen lds
    s_add_u32 s92, s92, 128
    s_and_b32 s92, s92, 1023
    s_add_u32 m0, s91, 57344
    s_nop 0
    buffer_load_dwordx4 v20, s[44:47], s82 offen lds
    s_add_u32 m0, s91, 58368
    s_nop 0
    buffer_load_dwordx4 v21, s[44:47], s82 offen lds
    s_waitcnt vmcnt(19)
    s_barrier
    s_add_u32 m0, s91, 59392
    s_nop 0
    buffer_load_dwordx4 v22, s[48:51], s82 offen lds
    s_add_u32 m0, s91, 60416
    s_nop 0
    buffer_load_dwordx4 v23, s[48:51], s82 offen lds
    s_add_u32 s82, s82, 229376
    s_cmp_ge_u32 s82, s46
    s_cselect_b32 s82, 0, s82
    s_add_u32 m0, s91, 81920
    s_nop 0
    buffer_load_dwordx4 v5, s[28:31], s92 offen lds
    s_add_u32 m0, s91, 82944
    s_nop 0
    buffer_load_dwordx4 v6, s[28:31], s92 offen lds
    s_add_u32 m0, s91, 83968
    s_nop 0
    buffer_load_dwordx4 v7, s[28:31], s92 offen lds
    s_add_u32 m0, s91, 84992
    s_nop 0
    buffer_load_dwordx4 v8, s[28:31], s92 offen lds
    s_add_u32 s92, s92, 128
    s_and_b32 s92, s92, 1023
    s_add_u32 m0, s91, 98304
    s_nop 0
    buffer_load_dwordx4 v20, s[44:47], s82 offen lds
    s_waitcnt vmcnt(14)
    v_cmp_gt_u32 vcc, 4, v44
    s_cbranch_vccz L_POLLTX
L_POLLT:
    buffer_load_dword v44, v27, s[24:27], s88 offen sc1
    s_add_u32 s68, s68, 1
    s_waitcnt vmcnt(0)
    v_cmp_gt_u32 vcc, 4, v44
    s_cmp_gt_u32 s68, 131072
    s_cbranch_scc1 L_POLLTX
    s_cbranch_vccz L_POLLTX
    s_sleep 8
    s_branch L_POLLT
L_POLLTX:
    s_add_u32 m0, s85, 114688
    s_nop 0
    buffer_load_dwordx4 v2, s[24:27], s84 offen sc1 lds
    s_add_u32 s84, s84, 4096
    s_add_u32 m0, s85, 118784
    s_nop 0
    buffer_load_dwordx4 v2, s[24:27], s84 offen sc1 lds
    s_add_u32 s84, s84, 4096
    s_waitcnt vmcnt(15)
    s_barrier
    s_add_u32 m0, s91, 99328
    s_nop 0
    buffer_load_dwordx4 v21, s[44:47], s82 offen lds
    s_add_u32 m0, s91, 100352
    s_nop 0
    buffer_load_dwordx4 v22, s[48:51], s82 offen lds
    s_add_u32 m0, s91, 101376
    s_nop 0
    buffer_load_dwordx4 v23, s[48:51], s82 offen lds
    s_add_u32 s82, s82, 229376
    s_cmp_ge_u32 s82, s46
    s_cselect_b32 s82, 0, s82
    s_add_u32 m0, s91, 122880
    s_nop 0
    buffer_load_dwordx4 v5, s[28:31], s92 offen lds
    s_add_u32 m0, s91, 123904
    s_nop 0
    buffer_load_dwordx4 v6, s[28:31], s92 offen lds
    s_add_u32 m0, s91, 124928
    s_nop 0
    buffer_load_dwordx4 v7, s[28:31], s92 offen lds
    s_add_u32 m0, s91, 125952
    s_nop 0
    buffer_load_dwordx4 v8, s[28:31], s92 offen lds
    s_add_u32 s92, s92, 128
    s_and_b32 s92, s92, 1023
    s_waitcnt vmcnt(14)
    s_barrier
    s_add_u32 m0, s91, 139264
    s_nop 0
    buffer_load_dwordx4 v20, s[44:47], s82 offen lds
    s_add_u32 m0, s91, 140288
    s_nop 0
    buffer_load_dwordx4 v21, s[44:47], s82 offen lds
    s_add_u32 m0, s91, 141312
    s_nop 0
    buffer_load_dwordx4 v22, s[48:51], s82 offen lds
    s_add_u32 m0, s91, 142336
    s_nop 0
    buffer_load_dwordx4 v23, s[48:51], s82 offen lds
    s_add_u32 s82, s82, 229376
    s_cmp_ge_u32 s82, s46
    s_cselect_b32 s82, 0, s82
    s_waitcnt vmcnt(8)
    s_barrier
    buffer_load_dword v28, v3, s[24:27], s69 offen sc1
    s_waitcnt vmcnt(1)
    s_barrier
    s_waitcnt vmcnt(0)
    v_cmp_gt_u32 vcc, 4, v28
    s_cbranch_vccz L_POLL1X
L_POLL1:
    buffer_load_dword v28, v3, s[24:27], s69 offen sc1
    s_add_u32 s68, s68, 1
    s_waitcnt vmcnt(0)
    v_cmp_gt_u32 vcc, 4, v28
    s_cmp_gt_u32 s68, 131072
    s_cbranch_scc1 L_POLL1X
    s_cbranch_vccz L_POLL1X
    s_sleep 8
    s_branch L_POLL1
L_POLL1X:
    s_add_u32 m0, s66, 155648
    s_nop 0
    buffer_load_dwordx4 v2, s[24:27], s65 offen sc1 lds
    buffer_load_dwordx4 v2, s[24:27], s65 offen offset:1024 sc1 lds
    s_add_u32 m0, s64, 0
    s_nop 0
    buffer_load_dwordx4 v2, s[24:27], s63 offen sc1 lds
    s_add_u32 s63, s63, 4096
    s_add_u32 m0, s64, 4160
    s_nop 0
    buffer_load_dwordx4 v2, s[24:27], s63 offen sc1 lds
    s_add_u32 s63, s63, 4096
    s_add_u32 m0, s64, 8320
    s_nop 0
    buffer_load_dwordx4 v2, s[24:27], s63 offen sc1 lds
    s_add_u32 s63, s63, 4096
    s_add_u32 m0, s64, 12480
    s_nop 0
    buffer_load_dwordx4 v2, s[24:27], s63 offen sc1 lds
    s_add_u32 s63, s63, 4096
    s_add_u32 m0, s64, 16640
    s_nop 0
    buffer_load_dwordx4 v2, s[24:27], s63 offen sc1 lds
    s_add_u32 s63, s63, 4096
    s_waitcnt vmcnt(0)
    s_barrier
    s_add_u32 m0, s64, 20800
    s_nop 0
    buffer_load_dwordx4 v2, s[24:27], s63 offen sc1 lds
    s_add_u32 s63, s63, 4096
    s_add_u32 m0, s64, 24960
    s_nop 0
    buffer_load_dwordx4 v2, s[24:27], s63 offen sc1 lds
    s_add_u32 s63, s63, 4096
    s_add_u32 m0, s64, 29120
    s_nop 0
    buffer_load_dwordx4 v2, s[24:27], s63 offen sc1 lds
    s_add_u32 s63, s63, 4096
    s_add_u32 m0, s64, 33280
    s_nop 0
    buffer_load_dwordx4 v2, s[24:27], s63 offen sc1 lds
    s_add_u32 s63, s63, 4096
    s_add_u32 m0, s64, 37440
    s_nop 0
    buffer_load_dwordx4 v2, s[24:27], s63 offen sc1 lds
    s_add_u32 s63, s63, 4096
    s_add_u32 m0, s64, 41600
    s_nop 0
    buffer_load_dwordx4 v2, s[24:27], s63 offen sc1 lds
    s_add_u32 s63, s63, 4096
    s_add_u32 m0, s64, 45760
    s_nop 0
    buffer_load_dwordx4 v2, s[24:27], s63 offen sc1 lds
    s_add_u32 s63, s63, 4096
    s_add_u32 m0, s64, 49920
    s_nop 0
    buffer_load_dwordx4 v2, s[24:27], s63 offen sc1 lds
    s_add_u32 s63, s63, 4096
    s_add_u32 m0, s64, 54080
    s_nop 0
    buffer_load_dwordx4 v2, s[24:27], s63 offen sc1 lds
    s_add_u32 s63, s63, 4096
    s_add_u32 m0, s64, 58240
    s_nop 0
    buffer_load_dwordx4 v2, s[24:27], s63 offen sc1 lds
    s_add_u32 s63, s63, 4096
    s_add_u32 m0, s64, 62400
    s_nop 0
    buffer_load_dwordx4 v2, s[24:27], s63 offen sc1 lds
    s_add_u32 s63, s63, 4096
    s_add_u32 m0, s64, 66560
    s_nop 0
    buffer_load_dwordx4 v2, s[24:27], s63 offen sc1 lds
    s_add_u32 s63, s63, 4096
    s_add_u32 m0, s64, 70720
    s_nop 0
    buffer_load_dwordx4 v2, s[24:27], s63 offen sc1 lds
    s_add_u32 s63, s63, 4096
    s_add_u32 m0, s64, 74880
    s_nop 0
    buffer_load_dwordx4 v2, s[24:27], s63 offen sc1 lds
    s_add_u32 s63, s63, 4096
    s_add_u32 m0, s64, 79040
    s_nop 0
    buffer_load_dwordx4 v2, s[24:27], s63 offen sc1 lds
    s_add_u32 s63, s63, 4096
    s_add_u32 m0, s64, 83200
    s_nop 0
    buffer_load_dwordx4 v2, s[24:27], s63 offen sc1 lds
    s_add_u32 s63, s63, 4096
    s_add_u32 m0, s64, 87360
    s_nop 0
    buffer_load_dwordx4 v2, s[24:27], s63 offen sc1 lds
    s_add_u32 s63, s63, 4096
    s_add_u32 m0, s64, 91520
    s_nop 0
    buffer_load_dwordx4 v2, s[24:27], s63 offen sc1 lds
    s_add_u32 s63, s63, 4096
    s_add_u32 m0, s64, 95680
    s_nop 0
    buffer_load_dwordx4 v2, s[24:27], s63 offen sc1 lds
    s_add_u32 s63, s63, 4096
    s_add_u32 m0, s64, 99840
    s_nop 0
    buffer_load_dwordx4 v2, s[24:27], s63 offen sc1 lds
    s_add_u32 s63, s63, 4096
    s_add_u32 m0, s64, 104000
    s_nop 0
    buffer_load_dwordx4 v2, s[24:27], s63 offen sc1 lds
    s_add_u32 s63, s63, 4096
    s_add_u32 m0, s64, 108160
    s_nop 0
    buffer_load_dwordx4 v2, s[24:27], s63 offen sc1 lds
    s_add_u32 s63, s63, 4096
    s_add_u32 m0, s64, 112320
    s_nop 0
    buffer_load_dwordx4 v2, s[24:27], s63 offen sc1 lds
    s_add_u32 s63, s63, 4096
    s_add_u32 m0, s64, 116480
    s_nop 0
    buffer_load_dwordx4 v2, s[24:27], s63 offen sc1 lds
    s_add_u32 s63, s63, 4096
    s_add_u32 m0, s64, 120640
    s_nop 0
    buffer_load_dwordx4 v2, s[24:27], s63 offen sc1 lds
    s_add_u32 s63, s63, 4096
    s_add_u32 m0, s64, 124800
    s_nop 0
    buffer_load_dwordx4 v2, s[24:27], s63 offen sc1 lds
    s_add_u32 s63, s63, 4096
    s_add_u32 m0, s64, 128960
    s_nop 0
    buffer_load_dwordx4 v2, s[24:27], s63 offen sc1 lds
    s_add_u32 s63, s63, 4096
    s_add_u32 m0, s89, 0
    s_add_u32 s63, s86, 0
    buffer_load_dwordx4 v18, s[52:55], s63 offen lds
    s_add_u32 m0, s89, 1024
    s_add_u32 s63, s86, 8192
    buffer_load_dwordx4 v18, s[52:55], s63 offen lds
    s_add_u32 m0, s89, 2048
    s_add_u32 s63, s86, 128
    buffer_load_dwordx4 v18, s[52:55], s63 offen lds
    s_add_u32 m0, s89, 3072
    s_add_u32 s63, s86, 8320
    buffer_load_dwordx4 v18, s[52:55], s63 offen lds
    s_lshr_b32 s63, s59, 1
    s_lshl_b32 s63, s63, 4
    v_add_u32 v3, s63, v17
    s_mul_i32 s64, s61, 28
    s_add_u32 s64, s64, 240
    v_add_u32 v4, s64, v17
    s_lshl_b32 s65, s61, 3
    s_add_u32 s65, s65, 368
    v_and_b32 v5, 7, v17
    v_add_u32 v5, s65, v5
    v_cmp_gt_u32 vcc, 44, v17
    s_nop 1
    v_cndmask_b32 v4, v5, v4, vcc
    v_cmp_gt_u32 vcc, 16, v17
    s_nop 1
    v_cndmask_b32 v3, v4, v3, vcc
    v_lshlrev_b32 v3, 7, v3
    s_waitcnt vmcnt(4)
    s_barrier
    s_waitcnt vmcnt(0)
    ds_read_b64_tr_b16 v[28:29], v24 offset:0
    ds_read_b64_tr_b16 v[30:31], v24 offset:1024
    ds_read_b64_tr_b16 v[32:33], v25 offset:0
    ds_read_b64_tr_b16 v[34:35], v25 offset:1024
    ds_read_b64_tr_b16 v[36:37], v24 offset:2048
    ds_read_b64_tr_b16 v[38:39], v24 offset:3072
    ds_read_b64_tr_b16 v[40:41], v25 offset:2048
    ds_read_b64_tr_b16 v[42:43], v25 offset:3072
    s_waitcnt lgkmcnt(0)
    buffer_store_dwordx4 v[28:31], v2, s[24:27], s87 offen sc1
    s_add_u32 s87, s87, 147456
    buffer_store_dwordx4 v[32:35], v2, s[24:27], s87 offen sc1
    s_add_u32 s87, s87, 147456
    buffer_store_dwordx4 v[36:39], v2, s[24:27], s87 offen sc1
    s_add_u32 s87, s87, 147456
    buffer_store_dwordx4 v[40:43], v2, s[24:27], s87 offen sc1
    s_add_u32 s87, s87, 147456
    s_waitcnt vmcnt(0)
    v_mov_b32 v44, 0
    v_mov_b32 v45, 4
    s_mov_b64 exec, 1
    buffer_store_dword v45, v44, s[24:27], s67 offen sc1
    s_mov_b64 exec, -1
    s_mov_b32 s69, 18874368
    s_barrier
L_POLL2:
    buffer_load_dwordx4 v[28:31], v3, s[24:27], s69 offen sc1
    s_add_u32 s68, s68, 1
    s_waitcnt vmcnt(0)
    v_min_u32 v28, v28, v29
    v_min3_u32 v28, v28, v30, v31
    v_cmp_gt_u32 vcc, 4, v28
    s_cmp_gt_u32 s68, 131072
    s_cbranch_scc1 L_POLL2X
    s_cbranch_vccz L_POLL2X
    s_sleep 32
    s_branch L_POLL2
L_POLL2X:
    v_mov_b32 v1, v17
    s_mul_i32 s63, s59, 294912
    s_mul_i32 s67, s61, 28672
    s_add_u32 s63, s63, s67
    s_add_u32 s63, s63, 6291456
    s_add_u32 s64, s63, 147456
    s_mul_i32 s65, s60, 294912
    s_add_u32 s65, s65, 15728640
    s_lshl_b32 s69, s61, 13
    s_add_u32 s69, s69, s65
    s_add_u32 s69, s69, 114688
    s_add_u32 s65, s65, s67
    s_add_u32 s66, s65, 147456
    buffer_load_dwordx4 v[176:179], v2, s[24:27], s69 offen offset:0 sc1
    buffer_load_dwordx4 v[180:183], v2, s[24:27], s69 offen offset:1024 sc1
    buffer_load_dwordx4 v[184:187], v2, s[24:27], s69 offen offset:2048 sc1
    buffer_load_dwordx4 v[188:191], v2, s[24:27], s69 offen offset:3072 sc1
    s_add_u32 s69, s69, 4096
    buffer_load_dwordx4 v[192:195], v2, s[24:27], s69 offen offset:0 sc1
    buffer_load_dwordx4 v[196:199], v2, s[24:27], s69 offen offset:1024 sc1
    buffer_load_dwordx4 v[200:203], v2, s[24:27], s69 offen offset:2048 sc1
    buffer_load_dwordx4 v[204:207], v2, s[24:27], s69 offen offset:3072 sc1
    s_add_u32 s69, s69, 143360
    buffer_load_dwordx4 v[208:211], v2, s[24:27], s69 offen offset:0 sc1
    buffer_load_dwordx4 v[212:215], v2, s[24:27], s69 offen offset:1024 sc1
    buffer_load_dwordx4 v[216:219], v2, s[24:27], s69 offen offset:2048 sc1
    buffer_load_dwordx4 v[220:223], v2, s[24:27], s69 offen offset:3072 sc1
    s_add_u32 s69, s69, 4096
    buffer_load_dwordx4 v[224:227], v2, s[24:27], s69 offen offset:0 sc1
    buffer_load_dwordx4 v[228:231], v2, s[24:27], s69 offen offset:1024 sc1
    buffer_load_dwordx4 v[232:235], v2, s[24:27], s69 offen offset:2048 sc1
    buffer_load_dwordx4 v[236:239], v2, s[24:27], s69 offen offset:3072 sc1
    s_add_u32 s69, s69, 143360
    s_mul_i32 s80, s59, 294912
    s_lshl_b32 s81, s61, 13
    s_add_u32 s80, s80, s81
    s_add_u32 s80, s80, 6406144
    s_add_u32 s81, s80, 147456
    s_add_u32 s82, s80, 4096
    s_add_u32 s83, s81, 4096
    s_mul_i32 s67, s61, 16896
    v_add_u32 v3, s67, v2
    v_and_b32 v4, 7, v1
    v_lshlrev_b32 v4, 2, v4
    s_lshl_b32 s67, s59, 2
    s_add_u32 s67, s67, s61
    s_lshl_b32 s67, s67, 7
    s_add_u32 s67, s67, 18939904
    s_lshl_b32 s84, s59, 6
    s_lshl_b32 s85, s56, 3
    s_add_u32 s84, s84, s85
    s_lshl_b32 s84, s84, 10
    s_lshl_b32 s85, s60, 7
    s_add_u32 s84, s84, s85
    v_lshrrev_b32 v246, 3, v1
    v_and_b32 v247, 7, v1
    v_lshlrev_b32 v244, 4, v247
    v_lshl_add_u32 v244, v246, 10, v244
    buffer_load_dwordx4 v[240:243], v244, s[28:31], s84 offen
    s_lshr_b32 s85, s56, 2
    s_mul_i32 s85, s85, 8448
    s_and_b32 s86, s56, 3
    s_lshl_b32 s86, s86, 7
    s_add_u32 s85, s85, s86
    v_mul_u32_u24 v245, 1056, v247
    v_lshl_add_u32 v245, v246, 4, v245
    v_add_u32 v245, s85, v245
    buffer_load_dwordx4 v[112:115], v2, s[24:27], s65 offen offset:0 sc1
    buffer_load_dwordx4 v[116:119], v2, s[24:27], s63 offen offset:0 sc1
    buffer_load_dwordx4 v[120:123], v2, s[24:27], s66 offen offset:0 sc1
    buffer_load_dwordx4 v[124:127], v2, s[24:27], s64 offen offset:0 sc1
    buffer_load_dwordx4 v[128:131], v2, s[24:27], s65 offen offset:1024 sc1
    buffer_load_dwordx4 v[132:135], v2, s[24:27], s63 offen offset:1024 sc1
    buffer_load_dwordx4 v[136:139], v2, s[24:27], s66 offen offset:1024 sc1
    buffer_load_dwordx4 v[140:143], v2, s[24:27], s64 offen offset:1024 sc1
    buffer_load_dwordx4 v[144:147], v2, s[24:27], s65 offen offset:2048 sc1
    buffer_load_dwordx4 v[148:151], v2, s[24:27], s63 offen offset:2048 sc1
    buffer_load_dwordx4 v[152:155], v2, s[24:27], s66 offen offset:2048 sc1
    buffer_load_dwordx4 v[156:159], v2, s[24:27], s64 offen offset:2048 sc1
    buffer_load_dwordx4 v[160:163], v2, s[24:27], s65 offen offset:3072 sc1
    buffer_load_dwordx4 v[164:167], v2, s[24:27], s63 offen offset:3072 sc1
    buffer_load_dwordx4 v[168:171], v2, s[24:27], s66 offen offset:3072 sc1
    buffer_load_dwordx4 v[172:175], v2, s[24:27], s64 offen offset:3072 sc1
    s_add_u32 s63, s63, 4096
    s_add_u32 s64, s64, 4096
    s_add_u32 s65, s65, 4096
    s_add_u32 s66, s66, 4096
    buffer_load_dwordx4 v[80:83], v2, s[24:27], s65 offen offset:0 sc1
    buffer_load_dwordx4 v[84:87], v2, s[24:27], s63 offen offset:0 sc1
    buffer_load_dwordx4 v[88:91], v2, s[24:27], s66 offen offset:0 sc1
    buffer_load_dwordx4 v[92:95], v2, s[24:27], s64 offen offset:0 sc1
    buffer_load_dwordx4 v[96:99], v2, s[24:27], s65 offen offset:1024 sc1
    buffer_load_dwordx4 v[100:103], v2, s[24:27], s63 offen offset:1024 sc1
    buffer_load_dwordx4 v[104:107], v2, s[24:27], s66 offen offset:1024 sc1
    buffer_load_dwordx4 v[108:111], v2, s[24:27], s64 offen offset:1024 sc1
    s_waitcnt vmcnt(20)
    v_mfma_f32_32x32x16_bf16 v[16:31], v[112:115], v[116:119], 0
    v_mfma_f32_32x32x16_bf16 v[32:47], v[112:115], v[124:127], 0
    v_mfma_f32_32x32x16_bf16 v[48:63], v[120:123], v[116:119], 0
    v_mfma_f32_32x32x16_bf16 v[64:79], v[120:123], v[124:127], 0
    buffer_load_dwordx4 v[112:115], v2, s[24:27], s65 offen offset:2048 sc1
    buffer_load_dwordx4 v[116:119], v2, s[24:27], s63 offen offset:2048 sc1
    buffer_load_dwordx4 v[120:123], v2, s[24:27], s66 offen offset:2048 sc1
    buffer_load_dwordx4 v[124:127], v2, s[24:27], s64 offen offset:2048 sc1
    s_waitcnt vmcnt(20)
    v_mfma_f32_32x32x16_bf16 v[16:31], v[128:131], v[132:135], v[16:31]
    v_mfma_f32_32x32x16_bf16 v[32:47], v[128:131], v[140:143], v[32:47]
    v_mfma_f32_32x32x16_bf16 v[48:63], v[136:139], v[132:135], v[48:63]
    v_mfma_f32_32x32x16_bf16 v[64:79], v[136:139], v[140:143], v[64:79]
    buffer_load_dwordx4 v[128:131], v2, s[24:27], s65 offen offset:3072 sc1
    buffer_load_dwordx4 v[132:135], v2, s[24:27], s63 offen offset:3072 sc1
    buffer_load_dwordx4 v[136:139], v2, s[24:27], s66 offen offset:3072 sc1
    buffer_load_dwordx4 v[140:143], v2, s[24:27], s64 offen offset:3072 sc1
    s_add_u32 s63, s63, 4096
    s_add_u32 s64, s64, 4096
    s_add_u32 s65, s65, 4096
    s_add_u32 s66, s66, 4096
    s_waitcnt vmcnt(20)
    v_mfma_f32_32x32x16_bf16 v[16:31], v[144:147], v[148:151], v[16:31]
    v_mfma_f32_32x32x16_bf16 v[32:47], v[144:147], v[156:159], v[32:47]
    v_mfma_f32_32x32x16_bf16 v[48:63], v[152:155], v[148:151], v[48:63]
    v_mfma_f32_32x32x16_bf16 v[64:79], v[152:155], v[156:159], v[64:79]
    buffer_load_dwordx4 v[144:147], v2, s[24:27], s65 offen offset:0 sc1
    buffer_load_dwordx4 v[148:151], v2, s[24:27], s63 offen offset:0 sc1
    buffer_load_dwordx4 v[152:155], v2, s[24:27], s66 offen offset:0 sc1
    buffer_load_dwordx4 v[156:159], v2, s[24:27], s64 offen offset:0 sc1
    s_waitcnt vmcnt(20)
    v_mfma_f32_32x32x16_bf16 v[16:31], v[160:163], v[164:167], v[16:31]
    v_mfma_f32_32x32x16_bf16 v[32:47], v[160:163], v[172:175], v[32:47]
    v_mfma_f32_32x32x16_bf16 v[48:63], v[168:171], v[164:167], v[48:63]
    v_mfma_f32_32x32x16_bf16 v[64:79], v[168:171], v[172:175], v[64:79]
    buffer_load_dwordx4 v[160:163], v2, s[24:27], s65 offen offset:1024 sc1
    buffer_load_dwordx4 v[164:167], v2, s[24:27], s63 offen offset:1024 sc1
    buffer_load_dwordx4 v[168:171], v2, s[24:27], s66 offen offset:1024 sc1
    buffer_load_dwordx4 v[172:175], v2, s[24:27], s64 offen offset:1024 sc1
    s_waitcnt vmcnt(20)
    v_mfma_f32_32x32x16_bf16 v[16:31], v[80:83], v[84:87], v[16:31]
    v_mfma_f32_32x32x16_bf16 v[32:47], v[80:83], v[92:95], v[32:47]
    v_mfma_f32_32x32x16_bf16 v[48:63], v[88:91], v[84:87], v[48:63]
    v_mfma_f32_32x32x16_bf16 v[64:79], v[88:91], v[92:95], v[64:79]
    buffer_load_dwordx4 v[80:83], v2, s[24:27], s65 offen offset:2048 sc1
    buffer_load_dwordx4 v[84:87], v2, s[24:27], s63 offen offset:2048 sc1
    buffer_load_dwordx4 v[88:91], v2, s[24:27], s66 offen offset:2048 sc1
    buffer_load_dwordx4 v[92:95], v2, s[24:27], s64 offen offset:2048 sc1
    s_waitcnt vmcnt(20)
    v_mfma_f32_32x32x16_bf16 v[16:31], v[96:99], v[100:103], v[16:31]
    v_mfma_f32_32x32x16_bf16 v[32:47], v[96:99], v[108:111], v[32:47]
    v_mfma_f32_32x32x16_bf16 v[48:63], v[104:107], v[100:103], v[48:63]
    v_mfma_f32_32x32x16_bf16 v[64:79], v[104:107], v[108:111], v[64:79]
    buffer_load_dwordx4 v[96:99], v2, s[24:27], s65 offen offset:3072 sc1
    buffer_load_dwordx4 v[100:103], v2, s[24:27], s63 offen offset:3072 sc1
    buffer_load_dwordx4 v[104:107], v2, s[24:27], s66 offen offset:3072 sc1
    buffer_load_dwordx4 v[108:111], v2, s[24:27], s64 offen offset:3072 sc1
    s_add_u32 s63, s63, 4096
    s_add_u32 s64, s64, 4096
    s_add_u32 s65, s65, 4096
    s_add_u32 s66, s66, 4096
    s_waitcnt vmcnt(20)
    v_mfma_f32_32x32x16_bf16 v[16:31], v[112:115], v[116:119], v[16:31]
    v_mfma_f32_32x32x16_bf16 v[32:47], v[112:115], v[124:127], v[32:47]
    v_mfma_f32_32x32x16_bf16 v[48:63], v[120:123], v[116:119], v[48:63]
    v_mfma_f32_32x32x16_bf16 v[64:79], v[120:123], v[124:127], v[64:79]
    buffer_load_dwordx4 v[112:115], v2, s[24:27], s65 offen offset:0 sc1
    buffer_load_dwordx4 v[116:119], v2, s[24:27], s63 offen offset:0 sc1
    buffer_load_dwordx4 v[120:123], v2, s[24:27], s66 offen offset:0 sc1
    buffer_load_dwordx4 v[124:127], v2, s[24:27], s64 offen offset:0 sc1
    s_waitcnt vmcnt(20)
    v_mfma_f32_32x32x16_bf16 v[16:31], v[128:131], v[132:135], v[16:31]
    v_mfma_f32_32x32x16_bf16 v[32:47], v[128:131], v[140:143], v[32:47]
    v_mfma_f32_32x32x16_bf16 v[48:63], v[136:139], v[132:135], v[48:63]
    v_mfma_f32_32x32x16_bf16 v[64:79], v[136:139], v[140:143], v[64:79]
    buffer_load_dwordx4 v[128:131], v2, s[24:27], s65 offen offset:1024 sc1
    buffer_load_dwordx4 v[132:135], v2, s[24:27], s63 offen offset:1024 sc1
    buffer_load_dwordx4 v[136:139], v2, s[24:27], s66 offen offset:1024 sc1
    buffer_load_dwordx4 v[140:143], v2, s[24:27], s64 offen offset:1024 sc1
    s_waitcnt vmcnt(20)
    v_mfma_f32_32x32x16_bf16 v[16:31], v[144:147], v[148:151], v[16:31]
    v_mfma_f32_32x32x16_bf16 v[32:47], v[144:147], v[156:159], v[32:47]
    v_mfma_f32_32x32x16_bf16 v[48:63], v[152:155], v[148:151], v[48:63]
    v_mfma_f32_32x32x16_bf16 v[64:79], v[152:155], v[156:159], v[64:79]
    buffer_load_dwordx4 v[144:147], v2, s[24:27], s65 offen offset:2048 sc1
    buffer_load_dwordx4 v[148:151], v2, s[24:27], s63 offen offset:2048 sc1
    buffer_load_dwordx4 v[152:155], v2, s[24:27], s66 offen offset:2048 sc1
    buffer_load_dwordx4 v[156:159], v2, s[24:27], s64 offen offset:2048 sc1
    s_waitcnt vmcnt(20)
    v_mfma_f32_32x32x16_bf16 v[16:31], v[160:163], v[164:167], v[16:31]
    v_mfma_f32_32x32x16_bf16 v[32:47], v[160:163], v[172:175], v[32:47]
    v_mfma_f32_32x32x16_bf16 v[48:63], v[168:171], v[164:167], v[48:63]
    v_mfma_f32_32x32x16_bf16 v[64:79], v[168:171], v[172:175], v[64:79]
    buffer_load_dwordx4 v[160:163], v2, s[24:27], s65 offen offset:3072 sc1
    buffer_load_dwordx4 v[164:167], v2, s[24:27], s63 offen offset:3072 sc1
    buffer_load_dwordx4 v[168:171], v2, s[24:27], s66 offen offset:3072 sc1
    buffer_load_dwordx4 v[172:175], v2, s[24:27], s64 offen offset:3072 sc1
    s_add_u32 s63, s63, 4096
    s_add_u32 s64, s64, 4096
    s_add_u32 s65, s65, 4096
    s_add_u32 s66, s66, 4096
    s_waitcnt vmcnt(20)
    v_mfma_f32_32x32x16_bf16 v[16:31], v[80:83], v[84:87], v[16:31]
    v_mfma_f32_32x32x16_bf16 v[32:47], v[80:83], v[92:95], v[32:47]
    v_mfma_f32_32x32x16_bf16 v[48:63], v[88:91], v[84:87], v[48:63]
    v_mfma_f32_32x32x16_bf16 v[64:79], v[88:91], v[92:95], v[64:79]
    buffer_load_dwordx4 v[80:83], v2, s[24:27], s65 offen offset:0 sc1
    buffer_load_dwordx4 v[84:87], v2, s[24:27], s63 offen offset:0 sc1
    buffer_load_dwordx4 v[88:91], v2, s[24:27], s66 offen offset:0 sc1
    buffer_load_dwordx4 v[92:95], v2, s[24:27], s64 offen offset:0 sc1
    s_waitcnt vmcnt(20)
    v_mfma_f32_32x32x16_bf16 v[16:31], v[96:99], v[100:103], v[16:31]
    v_mfma_f32_32x32x16_bf16 v[32:47], v[96:99], v[108:111], v[32:47]
    v_mfma_f32_32x32x16_bf16 v[48:63], v[104:107], v[100:103], v[48:63]
    v_mfma_f32_32x32x16_bf16 v[64:79], v[104:107], v[108:111], v[64:79]
    buffer_load_dwordx4 v[96:99], v2, s[24:27], s65 offen offset:1024 sc1
    buffer_load_dwordx4 v[100:103], v2, s[24:27], s63 offen offset:1024 sc1
    buffer_load_dwordx4 v[104:107], v2, s[24:27], s66 offen offset:1024 sc1
    buffer_load_dwordx4 v[108:111], v2, s[24:27], s64 offen offset:1024 sc1
    s_waitcnt vmcnt(20)
    v_mfma_f32_32x32x16_bf16 v[16:31], v[112:115], v[116:119], v[16:31]
    v_mfma_f32_32x32x16_bf16 v[32:47], v[112:115], v[124:127], v[32:47]
    v_mfma_f32_32x32x16_bf16 v[48:63], v[120:123], v[116:119], v[48:63]
    v_mfma_f32_32x32x16_bf16 v[64:79], v[120:123], v[124:127], v[64:79]
    buffer_load_dwordx4 v[112:115], v2, s[24:27], s65 offen offset:2048 sc1
    buffer_load_dwordx4 v[116:119], v2, s[24:27], s63 offen offset:2048 sc1
    buffer_load_dwordx4 v[120:123], v2, s[24:27], s66 offen offset:2048 sc1
    buffer_load_dwordx4 v[124:127], v2, s[24:27], s64 offen offset:2048 sc1
    s_waitcnt vmcnt(20)
    v_mfma_f32_32x32x16_bf16 v[16:31], v[128:131], v[132:135], v[16:31]
    v_mfma_f32_32x32x16_bf16 v[32:47], v[128:131], v[140:143], v[32:47]
    v_mfma_f32_32x32x16_bf16 v[48:63], v[136:139], v[132:135], v[48:63]
    v_mfma_f32_32x32x16_bf16 v[64:79], v[136:139], v[140:143], v[64:79]
    buffer_load_dwordx4 v[128:131], v2, s[24:27], s65 offen offset:3072 sc1
    buffer_load_dwordx4 v[132:135], v2, s[24:27], s63 offen offset:3072 sc1
    buffer_load_dwordx4 v[136:139], v2, s[24:27], s66 offen offset:3072 sc1
    buffer_load_dwordx4 v[140:143], v2, s[24:27], s64 offen offset:3072 sc1
    s_add_u32 s63, s63, 4096
    s_add_u32 s64, s64, 4096
    s_add_u32 s65, s65, 4096
    s_add_u32 s66, s66, 4096
    s_waitcnt vmcnt(20)
    v_mfma_f32_32x32x16_bf16 v[16:31], v[144:147], v[148:151], v[16:31]
    v_mfma_f32_32x32x16_bf16 v[32:47], v[144:147], v[156:159], v[32:47]
    v_mfma_f32_32x32x16_bf16 v[48:63], v[152:155], v[148:151], v[48:63]
    v_mfma_f32_32x32x16_bf16 v[64:79], v[152:155], v[156:159], v[64:79]
    buffer_load_dwordx4 v[144:147], v2, s[24:27], s65 offen offset:0 sc1
    buffer_load_dwordx4 v[148:151], v2, s[24:27], s63 offen offset:0 sc1
    buffer_load_dwordx4 v[152:155], v2, s[24:27], s66 offen offset:0 sc1
    buffer_load_dwordx4 v[156:159], v2, s[24:27], s64 offen offset:0 sc1
    s_waitcnt vmcnt(20)
    v_mfma_f32_32x32x16_bf16 v[16:31], v[160:163], v[164:167], v[16:31]
    v_mfma_f32_32x32x16_bf16 v[32:47], v[160:163], v[172:175], v[32:47]
    v_mfma_f32_32x32x16_bf16 v[48:63], v[168:171], v[164:167], v[48:63]
    v_mfma_f32_32x32x16_bf16 v[64:79], v[168:171], v[172:175], v[64:79]
    buffer_load_dwordx4 v[160:163], v2, s[24:27], s65 offen offset:1024 sc1
    buffer_load_dwordx4 v[164:167], v2, s[24:27], s63 offen offset:1024 sc1
    buffer_load_dwordx4 v[168:171], v2, s[24:27], s66 offen offset:1024 sc1
    buffer_load_dwordx4 v[172:175], v2, s[24:27], s64 offen offset:1024 sc1
    s_waitcnt vmcnt(20)
    v_mfma_f32_32x32x16_bf16 v[16:31], v[80:83], v[84:87], v[16:31]
    v_mfma_f32_32x32x16_bf16 v[32:47], v[80:83], v[92:95], v[32:47]
    v_mfma_f32_32x32x16_bf16 v[48:63], v[88:91], v[84:87], v[48:63]
    v_mfma_f32_32x32x16_bf16 v[64:79], v[88:91], v[92:95], v[64:79]
    buffer_load_dwordx4 v[80:83], v2, s[24:27], s65 offen offset:2048 sc1
    buffer_load_dwordx4 v[84:87], v2, s[24:27], s63 offen offset:2048 sc1
    buffer_load_dwordx4 v[88:91], v2, s[24:27], s66 offen offset:2048 sc1
    buffer_load_dwordx4 v[92:95], v2, s[24:27], s64 offen offset:2048 sc1
    s_waitcnt vmcnt(20)
    v_mfma_f32_32x32x16_bf16 v[16:31], v[96:99], v[100:103], v[16:31]
    v_mfma_f32_32x32x16_bf16 v[32:47], v[96:99], v[108:111], v[32:47]
    v_mfma_f32_32x32x16_bf16 v[48:63], v[104:107], v[100:103], v[48:63]
    v_mfma_f32_32x32x16_bf16 v[64:79], v[104:107], v[108:111], v[64:79]
    buffer_load_dwordx4 v[96:99], v2, s[24:27], s65 offen offset:3072 sc1
    buffer_load_dwordx4 v[100:103], v2, s[24:27], s63 offen offset:3072 sc1
    buffer_load_dwordx4 v[104:107], v2, s[24:27], s66 offen offset:3072 sc1
    buffer_load_dwordx4 v[108:111], v2, s[24:27], s64 offen offset:3072 sc1
    s_add_u32 s63, s63, 4096
    s_add_u32 s64, s64, 4096
    s_add_u32 s65, s65, 4096
    s_add_u32 s66, s66, 4096
    s_waitcnt vmcnt(20)
    v_mfma_f32_32x32x16_bf16 v[16:31], v[112:115], v[116:119], v[16:31]
    v_mfma_f32_32x32x16_bf16 v[32:47], v[112:115], v[124:127], v[32:47]
    v_mfma_f32_32x32x16_bf16 v[48:63], v[120:123], v[116:119], v[48:63]
    v_mfma_f32_32x32x16_bf16 v[64:79], v[120:123], v[124:127], v[64:79]
    buffer_load_dwordx4 v[112:115], v2, s[24:27], s65 offen offset:0 sc1
    buffer_load_dwordx4 v[116:119], v2, s[24:27], s63 offen offset:0 sc1
    buffer_load_dwordx4 v[120:123], v2, s[24:27], s66 offen offset:0 sc1
    buffer_load_dwordx4 v[124:127], v2, s[24:27], s64 offen offset:0 sc1
    s_waitcnt vmcnt(20)
    v_mfma_f32_32x32x16_bf16 v[16:31], v[128:131], v[132:135], v[16:31]
    v_mfma_f32_32x32x16_bf16 v[32:47], v[128:131], v[140:143], v[32:47]
    v_mfma_f32_32x32x16_bf16 v[48:63], v[136:139], v[132:135], v[48:63]
    v_mfma_f32_32x32x16_bf16 v[64:79], v[136:139], v[140:143], v[64:79]
    buffer_load_dwordx4 v[128:131], v2, s[24:27], s65 offen offset:1024 sc1
    buffer_load_dwordx4 v[132:135], v2, s[24:27], s63 offen offset:1024 sc1
    buffer_load_dwordx4 v[136:139], v2, s[24:27], s66 offen offset:1024 sc1
    buffer_load_dwordx4 v[140:143], v2, s[24:27], s64 offen offset:1024 sc1
    s_waitcnt vmcnt(20)
    v_mfma_f32_32x32x16_bf16 v[16:31], v[144:147], v[148:151], v[16:31]
    v_mfma_f32_32x32x16_bf16 v[32:47], v[144:147], v[156:159], v[32:47]
    v_mfma_f32_32x32x16_bf16 v[48:63], v[152:155], v[148:151], v[48:63]
    v_mfma_f32_32x32x16_bf16 v[64:79], v[152:155], v[156:159], v[64:79]
    buffer_load_dwordx4 v[144:147], v2, s[24:27], s65 offen offset:2048 sc1
    buffer_load_dwordx4 v[148:151], v2, s[24:27], s63 offen offset:2048 sc1
    buffer_load_dwordx4 v[152:155], v2, s[24:27], s66 offen offset:2048 sc1
    buffer_load_dwordx4 v[156:159], v2, s[24:27], s64 offen offset:2048 sc1
    s_waitcnt vmcnt(20)
    v_mfma_f32_32x32x16_bf16 v[16:31], v[160:163], v[164:167], v[16:31]
    v_mfma_f32_32x32x16_bf16 v[32:47], v[160:163], v[172:175], v[32:47]
    v_mfma_f32_32x32x16_bf16 v[48:63], v[168:171], v[164:167], v[48:63]
    v_mfma_f32_32x32x16_bf16 v[64:79], v[168:171], v[172:175], v[64:79]
    buffer_load_dwordx4 v[160:163], v2, s[24:27], s65 offen offset:3072 sc1
    buffer_load_dwordx4 v[164:167], v2, s[24:27], s63 offen offset:3072 sc1
    buffer_load_dwordx4 v[168:171], v2, s[24:27], s66 offen offset:3072 sc1
    buffer_load_dwordx4 v[172:175], v2, s[24:27], s64 offen offset:3072 sc1
    s_add_u32 s63, s63, 4096
    s_add_u32 s64, s64, 4096
    s_add_u32 s65, s65, 4096
    s_add_u32 s66, s66, 4096
    s_barrier
    s_waitcnt vmcnt(20)
    v_mfma_f32_32x32x16_bf16 v[16:31], v[80:83], v[84:87], v[16:31]
    v_mfma_f32_32x32x16_bf16 v[32:47], v[80:83], v[92:95], v[32:47]
    v_mfma_f32_32x32x16_bf16 v[48:63], v[88:91], v[84:87], v[48:63]
    v_mfma_f32_32x32x16_bf16 v[64:79], v[88:91], v[92:95], v[64:79]
    s_waitcnt vmcnt(16)
    v_mfma_f32_32x32x16_bf16 v[16:31], v[96:99], v[100:103], v[16:31]
    v_mfma_f32_32x32x16_bf16 v[32:47], v[96:99], v[108:111], v[32:47]
    v_mfma_f32_32x32x16_bf16 v[48:63], v[104:107], v[100:103], v[48:63]
    v_mfma_f32_32x32x16_bf16 v[64:79], v[104:107], v[108:111], v[64:79]
    s_waitcnt vmcnt(12)
    v_mfma_f32_32x32x16_bf16 v[16:31], v[112:115], v[116:119], v[16:31]
    v_mfma_f32_32x32x16_bf16 v[32:47], v[112:115], v[124:127], v[32:47]
    v_mfma_f32_32x32x16_bf16 v[48:63], v[120:123], v[116:119], v[48:63]
    v_mfma_f32_32x32x16_bf16 v[64:79], v[120:123], v[124:127], v[64:79]
    s_waitcnt vmcnt(8)
    v_mfma_f32_32x32x16_bf16 v[16:31], v[128:131], v[132:135], v[16:31]
    v_mfma_f32_32x32x16_bf16 v[32:47], v[128:131], v[140:143], v[32:47]
    v_mfma_f32_32x32x16_bf16 v[48:63], v[136:139], v[132:135], v[48:63]
    v_mfma_f32_32x32x16_bf16 v[64:79], v[136:139], v[140:143], v[64:79]
L_POLL3:
    buffer_load_dword v8, v4, s[24:27], s67 offen sc1
    s_add_u32 s68, s68, 1
    s_waitcnt vmcnt(0)
    v_cmp_gt_u32 vcc, 2, v8
    s_cmp_gt_u32 s68, 131072
    s_cbranch_scc1 L_POLL3X
    s_cbranch_vccz L_POLL3X
    s_sleep 2
    s_branch L_POLL3
L_POLL3X:
    buffer_load_dwordx4 v[80:83], v2, s[24:27], s80 offen offset:0 sc1
    buffer_load_dwordx4 v[84:87], v2, s[24:27], s81 offen offset:0 sc1
    buffer_load_dwordx4 v[88:91], v2, s[24:27], s80 offen offset:1024 sc1
    buffer_load_dwordx4 v[92:95], v2, s[24:27], s81 offen offset:1024 sc1
    buffer_load_dwordx4 v[96:99], v2, s[24:27], s80 offen offset:2048 sc1
    buffer_load_dwordx4 v[100:103], v2, s[24:27], s81 offen offset:2048 sc1
    buffer_load_dwordx4 v[104:107], v2, s[24:27], s80 offen offset:3072 sc1
    buffer_load_dwordx4 v[108:111], v2, s[24:27], s81 offen offset:3072 sc1
    buffer_load_dwordx4 v[112:115], v2, s[24:27], s82 offen offset:0 sc1
    buffer_load_dwordx4 v[116:119], v2, s[24:27], s83 offen offset:0 sc1
    buffer_load_dwordx4 v[120:123], v2, s[24:27], s82 offen offset:1024 sc1
    buffer_load_dwordx4 v[124:127], v2, s[24:27], s83 offen offset:1024 sc1
    buffer_load_dwordx4 v[128:131], v2, s[24:27], s82 offen offset:2048 sc1
    buffer_load_dwordx4 v[132:135], v2, s[24:27], s83 offen offset:2048 sc1
    buffer_load_dwordx4 v[136:139], v2, s[24:27], s82 offen offset:3072 sc1
    buffer_load_dwordx4 v[140:143], v2, s[24:27], s83 offen offset:3072 sc1
    v_mfma_f32_32x32x16_bf16 v[16:31], v[144:147], v[148:151], v[16:31]
    v_mfma_f32_32x32x16_bf16 v[32:47], v[144:147], v[156:159], v[32:47]
    v_mfma_f32_32x32x16_bf16 v[48:63], v[152:155], v[148:151], v[48:63]
    v_mfma_f32_32x32x16_bf16 v[64:79], v[152:155], v[156:159], v[64:79]
    v_mfma_f32_32x32x16_bf16 v[16:31], v[160:163], v[164:167], v[16:31]
    v_mfma_f32_32x32x16_bf16 v[32:47], v[160:163], v[172:175], v[32:47]
    v_mfma_f32_32x32x16_bf16 v[48:63], v[168:171], v[164:167], v[48:63]
    v_mfma_f32_32x32x16_bf16 v[64:79], v[168:171], v[172:175], v[64:79]
    s_waitcnt vmcnt(14)
    v_mfma_f32_32x32x16_bf16 v[16:31], v[176:179], v[80:83], v[16:31]
    v_mfma_f32_32x32x16_bf16 v[32:47], v[176:179], v[84:87], v[32:47]
    v_mfma_f32_32x32x16_bf16 v[48:63], v[208:211], v[80:83], v[48:63]
    v_mfma_f32_32x32x16_bf16 v[64:79], v[208:211], v[84:87], v[64:79]
    s_waitcnt vmcnt(12)
    v_mfma_f32_32x32x16_bf16 v[16:31], v[180:183], v[88:91], v[16:31]
    v_mfma_f32_32x32x16_bf16 v[32:47], v[180:183], v[92:95], v[32:47]
    v_mfma_f32_32x32x16_bf16 v[48:63], v[212:215], v[88:91], v[48:63]
    v_mfma_f32_32x32x16_bf16 v[64:79], v[212:215], v[92:95], v[64:79]
    s_waitcnt vmcnt(10)
    v_mfma_f32_32x32x16_bf16 v[16:31], v[184:187], v[96:99], v[16:31]
    v_mfma_f32_32x32x16_bf16 v[32:47], v[184:187], v[100:103], v[32:47]
    v_mfma_f32_32x32x16_bf16 v[48:63], v[216:219], v[96:99], v[48:63]
    v_mfma_f32_32x32x16_bf16 v[64:79], v[216:219], v[100:103], v[64:79]
    s_waitcnt vmcnt(8)
    v_mfma_f32_32x32x16_bf16 v[16:31], v[188:191], v[104:107], v[16:31]
    v_mfma_f32_32x32x16_bf16 v[32:47], v[188:191], v[108:111], v[32:47]
    v_mfma_f32_32x32x16_bf16 v[48:63], v[220:223], v[104:107], v[48:63]
    v_mfma_f32_32x32x16_bf16 v[64:79], v[220:223], v[108:111], v[64:79]
    s_waitcnt vmcnt(6)
    v_mfma_f32_32x32x16_bf16 v[16:31], v[192:195], v[112:115], v[16:31]
    v_mfma_f32_32x32x16_bf16 v[32:47], v[192:195], v[116:119], v[32:47]
    v_mfma_f32_32x32x16_bf16 v[48:63], v[224:227], v[112:115], v[48:63]
    v_mfma_f32_32x32x16_bf16 v[64:79], v[224:227], v[116:119], v[64:79]
    s_waitcnt vmcnt(4)
    v_mfma_f32_32x32x16_bf16 v[16:31], v[196:199], v[120:123], v[16:31]
    v_mfma_f32_32x32x16_bf16 v[32:47], v[196:199], v[124:127], v[32:47]
    v_mfma_f32_32x32x16_bf16 v[48:63], v[228:231], v[120:123], v[48:63]
    v_mfma_f32_32x32x16_bf16 v[64:79], v[228:231], v[124:127], v[64:79]
    s_waitcnt vmcnt(2)
    v_mfma_f32_32x32x16_bf16 v[16:31], v[200:203], v[128:131], v[16:31]
    v_mfma_f32_32x32x16_bf16 v[32:47], v[200:203], v[132:135], v[32:47]
    v_mfma_f32_32x32x16_bf16 v[48:63], v[232:235], v[128:131], v[48:63]
    v_mfma_f32_32x32x16_bf16 v[64:79], v[232:235], v[132:135], v[64:79]
    s_waitcnt vmcnt(0)
    v_mfma_f32_32x32x16_bf16 v[16:31], v[204:207], v[136:139], v[16:31]
    v_mfma_f32_32x32x16_bf16 v[32:47], v[204:207], v[140:143], v[32:47]
    v_mfma_f32_32x32x16_bf16 v[48:63], v[236:239], v[136:139], v[48:63]
    v_mfma_f32_32x32x16_bf16 v[64:79], v[236:239], v[140:143], v[64:79]
    s_nop 8
    ds_write_b128 v3, v[16:19] offset:0
    ds_write_b128 v3, v[20:23] offset:1056
    ds_write_b128 v3, v[24:27] offset:2112
    ds_write_b128 v3, v[28:31] offset:3168
    ds_write_b128 v3, v[32:35] offset:8448
    ds_write_b128 v3, v[36:39] offset:9504
    ds_write_b128 v3, v[40:43] offset:10560
    ds_write_b128 v3, v[44:47] offset:11616
    ds_write_b128 v3, v[48:51] offset:4224
    ds_write_b128 v3, v[52:55] offset:5280
    ds_write_b128 v3, v[56:59] offset:6336
    ds_write_b128 v3, v[60:63] offset:7392
    ds_write_b128 v3, v[64:67] offset:12672
    ds_write_b128 v3, v[68:71] offset:13728
    ds_write_b128 v3, v[72:75] offset:14784
    ds_write_b128 v3, v[76:79] offset:15840
    s_waitcnt lgkmcnt(0)
    s_branch L_REDUCE
L_COMPUTE:
    s_waitcnt lgkmcnt(0)
    s_mov_b32 s24, s22
    s_mov_b32 s25, s23
    s_mov_b32 s26, 19922944
    s_mov_b32 s27, 0x00020000
    s_mov_b32 s28, s4
    s_mov_b32 s29, s5
    s_mov_b32 s30, 2097152
    s_mov_b32 s31, 0x00020000
    s_lshl_b32 s63, s57, 7
    s_lshl_b32 s64, s58, 3
    s_add_u32 s63, s63, s64
    s_lshl_b32 s64, s56, 1
    s_add_u32 s77, s63, s64
    s_lshl_b32 s63, s77, 10
    v_lshlrev_b32 v56, 5, v17
    buffer_load_dwordx4 v[40:43], v56, s[28:31], s63 offen
    buffer_load_dwordx4 v[44:47], v56, s[28:31], s63 offen offset:16
    s_lshl_b32 s73, s60, 3
    s_lshl_b32 s64, s56, 1
    s_add_u32 s73, s73, s64
    s_mul_i32 s73, s73, 144
    s_add_u32 s73, s73, s59
    s_add_u32 s73, s73, 112
    s_lshl_b32 s73, s73, 10
    s_add_u32 s73, s73, 6291456
    s_add_u32 s74, s73, 147456
    s_lshl_b32 s72, s57, 4
    s_add_u32 s72, s72, s58
    s_lshl_b32 s72, s72, 7
    s_add_u32 s63, s72, 18874368
    s_lshl_b32 s64, s2, 7
    s_add_u32 s64, s64, 18907136
    s_lshl_b32 s99, s60, 2
    s_add_u32 s99, s99, s56
    s_lshl_b32 s99, s99, 2
    s_lshr_b32 s65, s59, 3
    s_add_u32 s99, s99, s65
    s_lshl_b32 s99, s99, 7
    s_and_b32 s65, s59, 7
    s_lshl_b32 s65, s65, 2
    s_add_u32 s99, s99, s65
    s_add_u32 s99, s99, 18939904
    v_lshlrev_b32 v19, 4, v17
    v_mov_b64 v[48:49], 0
    v_mov_b64 v[50:51], 0
    s_mov_b64 exec, 1
    buffer_store_dword v48, v48, s[24:27], s99 offen sc1
    s_cmp_lg_u32 s56, 0
    s_cbranch_scc1 L_NOCLR
    buffer_store_dwordx4 v[48:51], v48, s[24:27], s63 offen sc1
    buffer_store_dwordx4 v[48:51], v48, s[24:27], s64 offen sc1
    s_add_u32 s64, s72, 18972672
    buffer_store_dwordx4 v[48:51], v48, s[24:27], s64 offen sc1
    s_add_u32 s64, s72, 19005440
    buffer_store_dwordx4 v[48:51], v48, s[24:27], s64 offen sc1
    s_add_u32 s64, s72, 19038208
    buffer_store_dwordx4 v[48:51], v48, s[24:27], s64 offen sc1
L_NOCLR:
    s_mov_b64 exec, -1
    s_cmp_eq_u32 s56, 0
    s_cselect_b32 s72, s72, 19922944
    s_and_b32 s61, s56, 1
    s_lshr_b32 s62, s56, 1
    v_and_b32 v56, 15, v17
    v_lshrrev_b32 v57, 4, v17
    v_bfe_u32 v58, v17, 4, 1
    v_lshrrev_b32 v59, 5, v17
    v_bfe_u32 v60, v17, 1, 3
    v_xor_b32 v60, v60, v57
    v_lshlrev_b32 v60, 4, v60
    v_lshl_add_u32 v60, v56, 7, v60
    s_lshl_b32 s63, s61, 13
    s_add_u32 s63, s63, 40960
    v_add_u32 v2, s63, v60
    v_xor_b32 v3, 64, v2
    v_bfe_u32 v60, v17, 3, 1
    v_xor_b32 v60, s62, v60
    v_lshlrev_b32 v60, 2, v60
    v_and_b32 v61, 2, v17
    v_or3_b32 v60, v60, v61, v58
    v_lshlrev_b32 v60, 4, v60
    v_and_b32 v61, 1, v17
    v_lshl_add_u32 v60, v61, 3, v60
    v_bfe_u32 v61, v17, 2, 2
    v_lshl_add_u32 v60, v61, 7, v60
    v_lshl_add_u32 v60, v58, 10, v60
    v_mul_u32_u24 v4, 6144, v59
    v_add3_u32 v4, v4, v60, 0
    v_add_u32 v4, 57344, v4
    v_xor_b32 v5, 16, v4
    v_lshl_add_u32 v6, v59, 12, v60
    v_add_u32 v6, 16384, v6
    v_xor_b32 v7, 16, v6
    s_lshl_b32 s65, s61, 4
    s_lshr_b32 s63, s57, 3
    s_mul_i32 s64, s63, 12288
    s_lshl_b32 s63, s63, 13
    s_add_u32 s63, s63, 122880
    v_xor_b32 v120, s65, v4
    v_add_u32 v120, s64, v120
    v_xor_b32 v121, s65, v6
    v_add_u32 v121, s63, v121
    v_lshlrev_b32 v122, 2, v17
    s_mul_i32 s90, s58, 20480
    s_lshl_b32 s64, s57, 7
    s_add_u32 s90, s90, s64
    s_lshl_b32 s64, s62, 11
    s_add_u32 s90, s90, s64
    s_lshl_b32 s64, s61, 6
    s_add_u32 s90, s90, s64
    s_add_u32 s90, s90, 19398656
    v_lshlrev_b32 v60, 4, v56
    v_lshl_add_u32 v60, v58, 9, v60
    v_lshl_add_u32 v8, v59, 10, v60
    v_lshl_add_u32 v9, v59, 17, v60
    s_mul_i32 s63, s62, 40960
    s_lshl_b32 s64, s61, 12
    s_add_u32 s63, s63, s64
    s_add_u32 s63, s63, 32768
    v_lshlrev_b32 v60, 5, v56
    v_lshl_add_u32 v60, v58, 3, v60
    v_lshl_add_u32 v60, v59, 10, v60
    v_add_u32 v10, s63, v60
    v_bfe_u32 v60, v17, 2, 2
    v_lshl_add_u32 v60, v59, 2, v60
    v_lshlrev_b32 v60, 5, v60
    v_lshl_add_u32 v60, v58, 10, v60
    v_and_b32 v61, 3, v17
    v_lshl_add_u32 v60, v61, 3, v60
    v_add_u32 v11, s63, v60
    v_lshlrev_b32 v60, 4, v56
    v_lshl_add_u32 v60, v59, 8, v60
    v_lshl_add_u32 v12, v58, 17, v60
    v_add_u32 v0, 1024, v60
    v_add_u32 v1, 1536, v60
    v_cmp_ne_u32 vcc, 0, v56
    v_mov_b32 v60, 2048
    v_mov_b32 v61, 2064
    v_cndmask_b32 v60, v60, v61, vcc
    v_cmp_ne_u32 vcc, 0, v58
    s_lshl_b32 s63, s56, 11
    s_add_u32 s63, s63, 155648
    v_cndmask_b32 v0, v0, v60, vcc
    v_cndmask_b32 v1, v1, v60, vcc
    v_add_u32 v18, s63, v19
    s_lshl_b32 s63, s61, 10
    s_add_u32 s63, s63, 155648
    v_lshlrev_b32 v60, 4, v56
    v_add_u32 v13, s63, v60
    v_and_b32 v60, 31, v17
    v_lshlrev_b32 v60, 2, v60
    v_lshl_add_u32 v60, v59, 10, v60
    s_lshl_b32 s63, s62, 11
    v_add_u32 v14, s63, v60
    v_mov_b32 v20, 0x3f803f80
    v_mov_b32 v36, 4
    v_mov_b32 v21, 0x3f803f80
    v_mov_b32 v37, 4
    v_mov_b32 v22, 0x3f803f80
    v_mov_b32 v38, 4
    v_mov_b32 v23, 0x3f803f80
    v_mov_b32 v39, 4
    s_mov_b32 s94, 0xffff
    s_mov_b32 s95, 0
    s_mov_b32 s96, 0xffff0000
    s_mov_b32 s97, 0
    s_mov_b32 s98, 0x53800000
    s_lshl_b32 s68, s57, 2
    s_lshl_b32 s63, s61, 1
    s_add_u32 s68, s68, s63
    s_add_u32 s69, s68, 1
    s_and_b32 s63, s58, 7
    s_lshl_b32 s63, s63, 2
    s_lshl_b32 s64, s62, 1
    s_add_u32 s63, s63, s64
    s_lshl_b32 s63, s63, 6
    s_lshr_b32 s64, s58, 3
    s_lshl_b32 s64, s64, 10
    s_add_u32 s64, s64, 2097152
    s_add_u32 s80, s63, s68
    s_lshl_b32 s80, s80, 11
    s_add_u32 s80, s80, s64
    s_add_u32 s81, s63, s69
    s_lshl_b32 s81, s81, 11
    s_add_u32 s81, s81, s64
    s_mul_i32 s63, s68, 144
    s_lshl_b32 s64, s58, 2
    s_add_u32 s63, s63, s64
    s_lshl_b32 s64, s62, 1
    s_add_u32 s63, s63, s64
    s_lshl_b32 s63, s63, 10
    s_add_u32 s86, s63, 6291456
    s_add_u32 s63, s63, 6356992
    s_cmp_lt_u32 s58, 12
    s_cselect_b32 s82, s63, 19922944
    s_sub_u32 s63, s58, 12
    s_lshl_b32 s63, s63, 3
    s_add_u32 s63, s63, s64
    s_lshl_b32 s63, s63, 6
    s_add_u32 s63, s63, s68
    s_lshl_b32 s84, s63, 10
    s_mul_i32 s63, s69, 144
    s_lshl_b32 s64, s58, 2
    s_add_u32 s63, s63, s64
    s_lshl_b32 s64, s62, 1
    s_add_u32 s63, s63, s64
    s_lshl_b32 s63, s63, 10
    s_add_u32 s87, s63, 6291456
    s_add_u32 s63, s63, 6356992
    s_cmp_lt_u32 s58, 12
    s_cselect_b32 s83, s63, 19922944
    s_sub_u32 s63, s58, 12
    s_lshl_b32 s63, s63, 3
    s_add_u32 s63, s63, s64
    s_lshl_b32 s63, s63, 6
    s_add_u32 s63, s63, s69
    s_lshl_b32 s85, s63, 10
    s_mov_b32 s52, s20
    s_mov_b32 s53, s21
    s_mov_b32 s54, 256
    s_mov_b32 s55, 0x00020000
    v_mov_b32 v48, 0
    v_mov_b32 v49, 0
    s_mov_b32 s63, 0x3f803f80
    s_waitcnt vmcnt(0)
    v_dot2c_f32_bf16 v48, s63, v40
    v_dot2c_f32_bf16 v49, v40, v40
    v_dot2c_f32_bf16 v48, s63, v41
    v_dot2c_f32_bf16 v49, v41, v41
    v_dot2c_f32_bf16 v48, s63, v42
    v_dot2c_f32_bf16 v49, v42, v42
    v_dot2c_f32_bf16 v48, s63, v43
    v_dot2c_f32_bf16 v49, v43, v43
    v_dot2c_f32_bf16 v48, s63, v44
    v_dot2c_f32_bf16 v49, v44, v44
    v_dot2c_f32_bf16 v48, s63, v45
    v_dot2c_f32_bf16 v49, v45, v45
    v_dot2c_f32_bf16 v48, s63, v46
    v_dot2c_f32_bf16 v49, v46, v46
    v_dot2c_f32_bf16 v48, s63, v47
    v_dot2c_f32_bf16 v49, v47, v47
    s_nop 2
    v_add_f32_dpp v48, v48, v48 row_shr:1 row_mask:0xf bank_mask:0xf bound_ctrl:0
    v_add_f32_dpp v49, v49, v49 row_shr:1 row_mask:0xf bank_mask:0xf bound_ctrl:0
    s_nop 0
    v_add_f32_dpp v48, v48, v48 row_shr:2 row_mask:0xf bank_mask:0xf bound_ctrl:0
    v_add_f32_dpp v49, v49, v49 row_shr:2 row_mask:0xf bank_mask:0xf bound_ctrl:0
    s_nop 0
    v_add_f32_dpp v48, v48, v48 row_shr:4 row_mask:0xf bank_mask:0xf bound_ctrl:0
    v_add_f32_dpp v49, v49, v49 row_shr:4 row_mask:0xf bank_mask:0xf bound_ctrl:0
    s_nop 0
    v_add_f32_dpp v48, v48, v48 row_shr:8 row_mask:0xf bank_mask:0xf bound_ctrl:0
    v_add_f32_dpp v49, v49, v49 row_shr:8 row_mask:0xf bank_mask:0xf bound_ctrl:0
    s_nop 0
    v_add_f32_dpp v48, v48, v48 row_bcast:15 row_mask:0xa bank_mask:0xf
    v_add_f32_dpp v49, v49, v49 row_bcast:15 row_mask:0xa bank_mask:0xf
    v_mul_f32 v48, 0xbb000000, v48
    v_mul_f32 v49, 0x3b000000, v49
    v_fma_f32 v49, -v48, v48, v49
    v_max_f32 v49, 0, v49
    v_add_f32 v67, 0x3727c5ac, v49
    v_rsq_f32 v66, v67
    v_cvt_pk_bf16_f32 v64, v48, v48
    v_and_b32 v65, 0xffff0000, v64
    v_sub_f32 v65, v48, v65
    v_cvt_pk_bf16_f32 v65, v65, v65
    v_lshlrev_b32 v59, 4, v59
    s_lshl_b32 s63, s77, 4
    s_add_u32 s63, s63, 19857408
    s_mov_b32 s64, 0x80000000
    s_mov_b32 s65, 0x80000000
    s_mov_b64 exec, s[64:65]
    buffer_store_dwordx4 v[64:67], v59, s[24:27], s63 offen sc1
    s_mov_b64 exec, -1
    s_barrier
    ds_read_b128 v[40:43], v2 offset:0
    ds_read_b64_tr_b16 v[72:73], v4 offset:0
    ds_read_b64_tr_b16 v[74:75], v4 offset:512
    ds_read_b128 v[44:47], v2 offset:2048
    ds_read_b128 v[48:51], v2 offset:4096
    ds_read_b128 v[52:55], v2 offset:6144
    ds_read_b64_tr_b16 v[76:77], v5 offset:0
    ds_read_b64_tr_b16 v[78:79], v5 offset:512
    ds_read_b64_tr_b16 v[80:81], v4 offset:2048
    ds_read_b64_tr_b16 v[82:83], v4 offset:2560
    ds_read_b64_tr_b16 v[84:85], v5 offset:2048
    ds_read_b64_tr_b16 v[86:87], v5 offset:2560
    ds_read_b64_tr_b16 v[88:89], v4 offset:4096
    ds_read_b64_tr_b16 v[90:91], v4 offset:4608
    ds_read_b64_tr_b16 v[92:93], v5 offset:4096
    ds_read_b64_tr_b16 v[94:95], v5 offset:4608
    ds_read_b64_tr_b16 v[224:225], v120 offset:0
    ds_read_b64_tr_b16 v[226:227], v120 offset:512
    ds_read_b64_tr_b16 v[228:229], v120 offset:2048
    ds_read_b64_tr_b16 v[230:231], v120 offset:2560
    ds_read_b64_tr_b16 v[232:233], v120 offset:4096
    ds_read_b64_tr_b16 v[234:235], v120 offset:4608
    s_cmp_lg_u32 s56, 0
    s_cbranch_scc1 L_NOCNT
    v_mov_b32 v15, 0
    v_mov_b32 v16, 1
    s_and_b32 s63, s2, 1
    s_lshl_b32 s63, s63, 7
    s_mov_b64 exec, 1
    buffer_atomic_add v16, v15, s[52:55], s63 offen sc1
    s_mov_b64 exec, -1
L_NOCNT:
    s_waitcnt lgkmcnt(0)
    v_mfma_f32_16x16x32_bf16 v[24:27], v[20:23], v[224:227], 0
    v_mfma_f32_16x16x32_bf16 v[28:31], v[20:23], v[228:231], 0
    v_mfma_f32_16x16x32_bf16 v[32:35], v[20:23], v[232:235], 0
    v_mfma_f32_16x16x32_bf16 v[128:131], v[72:75], v[40:43], 0
    ds_read_b128 v[56:59], v3 offset:0
    v_mfma_f32_16x16x32_bf16 v[144:147], v[72:75], v[44:47], 0
    ds_read_b64_tr_b16 v[96:97], v4 offset:12288
    v_mfma_f32_16x16x32_bf16 v[160:163], v[72:75], v[48:51], 0
    ds_read_b64_tr_b16 v[98:99], v4 offset:12800
    v_mfma_f32_16x16x32_bf16 v[176:179], v[72:75], v[52:55], 0
    ds_read_b128 v[60:63], v3 offset:2048
    v_mfma_f32_16x16x32_bf16 v[132:135], v[76:79], v[40:43], 0
    ds_read_b128 v[64:67], v3 offset:4096
    v_mfma_f32_16x16x32_bf16 v[148:151], v[76:79], v[44:47], 0
    ds_read_b128 v[68:71], v3 offset:6144
    v_mfma_f32_16x16x32_bf16 v[164:167], v[76:79], v[48:51], 0
    ds_read_b64_tr_b16 v[100:101], v5 offset:12288
    v_mfma_f32_16x16x32_bf16 v[180:183], v[76:79], v[52:55], 0
    ds_read_b64_tr_b16 v[102:103], v5 offset:12800
    v_mfma_f32_16x16x32_bf16 v[136:139], v[80:83], v[40:43], 0
    ds_read_b64_tr_b16 v[104:105], v4 offset:14336
    v_mfma_f32_16x16x32_bf16 v[152:155], v[80:83], v[44:47], 0
    ds_read_b64_tr_b16 v[106:107], v4 offset:14848
    v_mfma_f32_16x16x32_bf16 v[168:171], v[80:83], v[48:51], 0
    ds_read_b64_tr_b16 v[108:109], v5 offset:14336
    v_mfma_f32_16x16x32_bf16 v[184:187], v[80:83], v[52:55], 0
    ds_read_b64_tr_b16 v[110:111], v5 offset:14848
    v_mfma_f32_16x16x32_bf16 v[140:143], v[84:87], v[40:43], 0
    ds_read_b64_tr_b16 v[112:113], v4 offset:16384
    v_mfma_f32_16x16x32_bf16 v[156:159], v[84:87], v[44:47], 0
    ds_read_b64_tr_b16 v[114:115], v4 offset:16896
    v_mfma_f32_16x16x32_bf16 v[172:175], v[84:87], v[48:51], 0
    ds_read_b64_tr_b16 v[116:117], v5 offset:16384
    v_mfma_f32_16x16x32_bf16 v[188:191], v[84:87], v[52:55], 0
    ds_read_b64_tr_b16 v[118:119], v5 offset:16896
    v_mfma_f32_16x16x32_bf16 v[192:195], v[88:91], v[40:43], 0
    v_mfma_f32_16x16x32_bf16 v[200:203], v[88:91], v[44:47], 0
    v_mfma_f32_16x16x32_bf16 v[208:211], v[88:91], v[48:51], 0
    v_mfma_f32_16x16x32_bf16 v[216:219], v[88:91], v[52:55], 0
    v_mfma_f32_16x16x32_bf16 v[196:199], v[92:95], v[40:43], 0
    v_mfma_f32_16x16x32_bf16 v[204:207], v[92:95], v[44:47], 0
    v_mfma_f32_16x16x32_bf16 v[212:215], v[92:95], v[48:51], 0
    v_mfma_f32_16x16x32_bf16 v[220:223], v[92:95], v[52:55], 0
    s_mov_b64 exec, s[94:95]
    s_add_u32 s63, s90, 0
    buffer_store_dword v24, v122, s[24:27], s63 offen sc1
    s_add_u32 s63, s90, 4096
    buffer_store_dword v28, v122, s[24:27], s63 offen sc1
    s_add_u32 s63, s90, 8192
    buffer_store_dword v32, v122, s[24:27], s63 offen sc1
    s_mov_b64 exec, -1
    s_waitcnt lgkmcnt(8)
    v_mfma_f32_16x16x32_bf16 v[128:131], v[96:99], v[56:59], v[128:131]
    v_mfma_f32_16x16x32_bf16 v[144:147], v[96:99], v[60:63], v[144:147]
    v_mfma_f32_16x16x32_bf16 v[160:163], v[96:99], v[64:67], v[160:163]
    v_mfma_f32_16x16x32_bf16 v[176:179], v[96:99], v[68:71], v[176:179]
    s_waitcnt lgkmcnt(0)
    s_barrier
    v_mfma_f32_16x16x32_bf16 v[132:135], v[100:103], v[56:59], v[132:135]
    ds_read_b128 v[40:43], v2 offset:40960
    v_mfma_f32_16x16x32_bf16 v[148:151], v[100:103], v[60:63], v[148:151]
    ds_read_b64_tr_b16 v[72:73], v4 offset:40960
    v_mfma_f32_16x16x32_bf16 v[164:167], v[100:103], v[64:67], v[164:167]
    ds_read_b64_tr_b16 v[74:75], v4 offset:41472
    v_mfma_f32_16x16x32_bf16 v[180:183], v[100:103], v[68:71], v[180:183]
    ds_read_b128 v[44:47], v2 offset:43008
    v_mfma_f32_16x16x32_bf16 v[136:139], v[104:107], v[56:59], v[136:139]
    ds_read_b128 v[48:51], v2 offset:45056
    v_mfma_f32_16x16x32_bf16 v[152:155], v[104:107], v[60:63], v[152:155]
    ds_read_b128 v[52:55], v2 offset:47104
    v_mfma_f32_16x16x32_bf16 v[168:171], v[104:107], v[64:67], v[168:171]
    ds_read_b64_tr_b16 v[76:77], v5 offset:40960
    v_mfma_f32_16x16x32_bf16 v[184:187], v[104:107], v[68:71], v[184:187]
    ds_read_b64_tr_b16 v[78:79], v5 offset:41472
    v_mfma_f32_16x16x32_bf16 v[140:143], v[108:111], v[56:59], v[140:143]
    ds_read_b64_tr_b16 v[80:81], v4 offset:43008
    v_mfma_f32_16x16x32_bf16 v[156:159], v[108:111], v[60:63], v[156:159]
    ds_read_b64_tr_b16 v[82:83], v4 offset:43520
    v_mfma_f32_16x16x32_bf16 v[172:175], v[108:111], v[64:67], v[172:175]
    ds_read_b64_tr_b16 v[84:85], v5 offset:43008
    v_mfma_f32_16x16x32_bf16 v[188:191], v[108:111], v[68:71], v[188:191]
    ds_read_b64_tr_b16 v[86:87], v5 offset:43520
    v_mfma_f32_16x16x32_bf16 v[192:195], v[112:115], v[56:59], v[192:195]
    ds_read_b64_tr_b16 v[88:89], v4 offset:45056
    v_mfma_f32_16x16x32_bf16 v[200:203], v[112:115], v[60:63], v[200:203]
    ds_read_b64_tr_b16 v[90:91], v4 offset:45568
    v_mfma_f32_16x16x32_bf16 v[208:211], v[112:115], v[64:67], v[208:211]
    ds_read_b64_tr_b16 v[92:93], v5 offset:45056
    v_mfma_f32_16x16x32_bf16 v[216:219], v[112:115], v[68:71], v[216:219]
    ds_read_b64_tr_b16 v[94:95], v5 offset:45568
    v_mfma_f32_16x16x32_bf16 v[196:199], v[116:119], v[56:59], v[196:199]
    v_mfma_f32_16x16x32_bf16 v[204:207], v[116:119], v[60:63], v[204:207]
    v_mfma_f32_16x16x32_bf16 v[212:215], v[116:119], v[64:67], v[212:215]
    v_mfma_f32_16x16x32_bf16 v[220:223], v[116:119], v[68:71], v[220:223]
    s_waitcnt lgkmcnt(8)
    v_mfma_f32_16x16x32_bf16 v[128:131], v[72:75], v[40:43], v[128:131]
    ds_read_b128 v[56:59], v3 offset:40960
    v_mfma_f32_16x16x32_bf16 v[144:147], v[72:75], v[44:47], v[144:147]
    ds_read_b64_tr_b16 v[96:97], v4 offset:53248
    v_mfma_f32_16x16x32_bf16 v[160:163], v[72:75], v[48:51], v[160:163]
    ds_read_b64_tr_b16 v[98:99], v4 offset:53760
    v_mfma_f32_16x16x32_bf16 v[176:179], v[72:75], v[52:55], v[176:179]
    ds_read_b128 v[60:63], v3 offset:43008
    v_mfma_f32_16x16x32_bf16 v[132:135], v[76:79], v[40:43], v[132:135]
    ds_read_b128 v[64:67], v3 offset:45056
    v_mfma_f32_16x16x32_bf16 v[148:151], v[76:79], v[44:47], v[148:151]
    ds_read_b128 v[68:71], v3 offset:47104
    v_mfma_f32_16x16x32_bf16 v[164:167], v[76:79], v[48:51], v[164:167]
    ds_read_b64_tr_b16 v[100:101], v5 offset:53248
    v_mfma_f32_16x16x32_bf16 v[180:183], v[76:79], v[52:55], v[180:183]
    ds_read_b64_tr_b16 v[102:103], v5 offset:53760
    s_waitcnt lgkmcnt(8)
    v_mfma_f32_16x16x32_bf16 v[136:139], v[80:83], v[40:43], v[136:139]
    ds_read_b64_tr_b16 v[104:105], v4 offset:55296
    v_mfma_f32_16x16x32_bf16 v[152:155], v[80:83], v[44:47], v[152:155]
    ds_read_b64_tr_b16 v[106:107], v4 offset:55808
    v_mfma_f32_16x16x32_bf16 v[168:171], v[80:83], v[48:51], v[168:171]
    ds_read_b64_tr_b16 v[108:109], v5 offset:55296
    v_mfma_f32_16x16x32_bf16 v[184:187], v[80:83], v[52:55], v[184:187]
    ds_read_b64_tr_b16 v[110:111], v5 offset:55808
    v_mfma_f32_16x16x32_bf16 v[140:143], v[84:87], v[40:43], v[140:143]
    ds_read_b64_tr_b16 v[112:113], v4 offset:57344
    v_mfma_f32_16x16x32_bf16 v[156:159], v[84:87], v[44:47], v[156:159]
    ds_read_b64_tr_b16 v[114:115], v4 offset:57856
    v_mfma_f32_16x16x32_bf16 v[172:175], v[84:87], v[48:51], v[172:175]
    ds_read_b64_tr_b16 v[116:117], v5 offset:57344
    v_mfma_f32_16x16x32_bf16 v[188:191], v[84:87], v[52:55], v[188:191]
    ds_read_b64_tr_b16 v[118:119], v5 offset:57856
    v_mfma_f32_16x16x32_bf16 v[192:195], v[88:91], v[40:43], v[192:195]
    v_mfma_f32_16x16x32_bf16 v[200:203], v[88:91], v[44:47], v[200:203]
    v_mfma_f32_16x16x32_bf16 v[208:211], v[88:91], v[48:51], v[208:211]
    v_mfma_f32_16x16x32_bf16 v[216:219], v[88:91], v[52:55], v[216:219]
    v_mfma_f32_16x16x32_bf16 v[196:199], v[92:95], v[40:43], v[196:199]
    v_mfma_f32_16x16x32_bf16 v[204:207], v[92:95], v[44:47], v[204:207]
    v_mfma_f32_16x16x32_bf16 v[212:215], v[92:95], v[48:51], v[212:215]
    v_mfma_f32_16x16x32_bf16 v[220:223], v[92:95], v[52:55], v[220:223]
    s_waitcnt lgkmcnt(8)
    v_mfma_f32_16x16x32_bf16 v[128:131], v[96:99], v[56:59], v[128:131]
    v_mfma_f32_16x16x32_bf16 v[144:147], v[96:99], v[60:63], v[144:147]
    v_mfma_f32_16x16x32_bf16 v[160:163], v[96:99], v[64:67], v[160:163]
    v_mfma_f32_16x16x32_bf16 v[176:179], v[96:99], v[68:71], v[176:179]
    s_waitcnt vmcnt(0)
    s_waitcnt lgkmcnt(0)
    s_barrier
    v_mfma_f32_16x16x32_bf16 v[132:135], v[100:103], v[56:59], v[132:135]
    v_subrev_u32 v4, 40960, v4
    v_subrev_u32 v5, 40960, v5
    v_mfma_f32_16x16x32_bf16 v[148:151], v[100:103], v[60:63], v[148:151]
    v_subrev_u32 v2, 40960, v2
    v_subrev_u32 v3, 40960, v3
    v_mfma_f32_16x16x32_bf16 v[164:167], v[100:103], v[64:67], v[164:167]
    ds_read_b128 v[40:43], v2 offset:0
    v_mfma_f32_16x16x32_bf16 v[180:183], v[100:103], v[68:71], v[180:183]
    ds_read_b64_tr_b16 v[72:73], v4 offset:0
    v_mfma_f32_16x16x32_bf16 v[136:139], v[104:107], v[56:59], v[136:139]
    ds_read_b64_tr_b16 v[74:75], v4 offset:512
    v_mfma_f32_16x16x32_bf16 v[152:155], v[104:107], v[60:63], v[152:155]
    ds_read_b128 v[44:47], v2 offset:2048
    v_mfma_f32_16x16x32_bf16 v[168:171], v[104:107], v[64:67], v[168:171]
    ds_read_b128 v[48:51], v2 offset:4096
    v_mfma_f32_16x16x32_bf16 v[184:187], v[104:107], v[68:71], v[184:187]
    ds_read_b128 v[52:55], v2 offset:6144
    v_mfma_f32_16x16x32_bf16 v[140:143], v[108:111], v[56:59], v[140:143]
    ds_read_b64_tr_b16 v[76:77], v5 offset:0
    v_mfma_f32_16x16x32_bf16 v[156:159], v[108:111], v[60:63], v[156:159]
    ds_read_b64_tr_b16 v[78:79], v5 offset:512
    v_mfma_f32_16x16x32_bf16 v[172:175], v[108:111], v[64:67], v[172:175]
    ds_read_b64_tr_b16 v[80:81], v4 offset:2048
    v_mfma_f32_16x16x32_bf16 v[188:191], v[108:111], v[68:71], v[188:191]
    ds_read_b64_tr_b16 v[82:83], v4 offset:2560
    v_mfma_f32_16x16x32_bf16 v[192:195], v[112:115], v[56:59], v[192:195]
    ds_read_b64_tr_b16 v[84:85], v5 offset:2048
    v_mfma_f32_16x16x32_bf16 v[200:203], v[112:115], v[60:63], v[200:203]
    ds_read_b64_tr_b16 v[86:87], v5 offset:2560
    v_mfma_f32_16x16x32_bf16 v[208:211], v[112:115], v[64:67], v[208:211]
    ds_read_b64_tr_b16 v[88:89], v4 offset:4096
    v_mfma_f32_16x16x32_bf16 v[216:219], v[112:115], v[68:71], v[216:219]
    ds_read_b64_tr_b16 v[90:91], v4 offset:4608
    v_mfma_f32_16x16x32_bf16 v[196:199], v[116:119], v[56:59], v[196:199]
    ds_read_b64_tr_b16 v[92:93], v5 offset:4096
    v_mfma_f32_16x16x32_bf16 v[204:207], v[116:119], v[60:63], v[204:207]
    ds_read_b64_tr_b16 v[94:95], v5 offset:4608
    v_mfma_f32_16x16x32_bf16 v[212:215], v[116:119], v[64:67], v[212:215]
    v_mfma_f32_16x16x32_bf16 v[220:223], v[116:119], v[68:71], v[220:223]
    v_mov_b32 v15, 18972672
    s_mov_b64 exec, 1
    buffer_store_dwordx4 v[36:39], v15, s[24:27], s72 offen sc1
    s_mov_b64 exec, -1
    s_waitcnt lgkmcnt(8)
    v_mfma_f32_16x16x32_bf16 v[128:131], v[72:75], v[40:43], v[128:131]
    ds_read_b128 v[56:59], v3 offset:0
    v_mfma_f32_16x16x32_bf16 v[144:147], v[72:75], v[44:47], v[144:147]
    ds_read_b64_tr_b16 v[96:97], v4 offset:12288
    v_mfma_f32_16x16x32_bf16 v[160:163], v[72:75], v[48:51], v[160:163]
    ds_read_b64_tr_b16 v[98:99], v4 offset:12800
    v_mfma_f32_16x16x32_bf16 v[176:179], v[72:75], v[52:55], v[176:179]
    ds_read_b128 v[60:63], v3 offset:2048
    v_mfma_f32_16x16x32_bf16 v[132:135], v[76:79], v[40:43], v[132:135]
    ds_read_b128 v[64:67], v3 offset:4096
    v_mfma_f32_16x16x32_bf16 v[148:151], v[76:79], v[44:47], v[148:151]
    ds_read_b128 v[68:71], v3 offset:6144
    v_mfma_f32_16x16x32_bf16 v[164:167], v[76:79], v[48:51], v[164:167]
    ds_read_b64_tr_b16 v[100:101], v5 offset:12288
    v_mfma_f32_16x16x32_bf16 v[180:183], v[76:79], v[52:55], v[180:183]
    ds_read_b64_tr_b16 v[102:103], v5 offset:12800
    s_waitcnt lgkmcnt(8)
    v_mfma_f32_16x16x32_bf16 v[136:139], v[80:83], v[40:43], v[136:139]
    ds_read_b64_tr_b16 v[104:105], v4 offset:14336
    v_mfma_f32_16x16x32_bf16 v[152:155], v[80:83], v[44:47], v[152:155]
    ds_read_b64_tr_b16 v[106:107], v4 offset:14848
    v_mfma_f32_16x16x32_bf16 v[168:171], v[80:83], v[48:51], v[168:171]
    ds_read_b64_tr_b16 v[108:109], v5 offset:14336
    v_mfma_f32_16x16x32_bf16 v[184:187], v[80:83], v[52:55], v[184:187]
    ds_read_b64_tr_b16 v[110:111], v5 offset:14848
    v_mfma_f32_16x16x32_bf16 v[140:143], v[84:87], v[40:43], v[140:143]
    ds_read_b64_tr_b16 v[112:113], v4 offset:16384
    v_mfma_f32_16x16x32_bf16 v[156:159], v[84:87], v[44:47], v[156:159]
    ds_read_b64_tr_b16 v[114:115], v4 offset:16896
    v_mfma_f32_16x16x32_bf16 v[172:175], v[84:87], v[48:51], v[172:175]
    ds_read_b64_tr_b16 v[116:117], v5 offset:16384
    v_mfma_f32_16x16x32_bf16 v[188:191], v[84:87], v[52:55], v[188:191]
    ds_read_b64_tr_b16 v[118:119], v5 offset:16896
    v_mfma_f32_16x16x32_bf16 v[192:195], v[88:91], v[40:43], v[192:195]
    v_mfma_f32_16x16x32_bf16 v[200:203], v[88:91], v[44:47], v[200:203]
    v_mfma_f32_16x16x32_bf16 v[208:211], v[88:91], v[48:51], v[208:211]
    v_mfma_f32_16x16x32_bf16 v[216:219], v[88:91], v[52:55], v[216:219]
    v_mfma_f32_16x16x32_bf16 v[196:199], v[92:95], v[40:43], v[196:199]
    v_mfma_f32_16x16x32_bf16 v[204:207], v[92:95], v[44:47], v[204:207]
    v_mfma_f32_16x16x32_bf16 v[212:215], v[92:95], v[48:51], v[212:215]
    v_mfma_f32_16x16x32_bf16 v[220:223], v[92:95], v[52:55], v[220:223]
    s_waitcnt lgkmcnt(8)
    v_mfma_f32_16x16x32_bf16 v[128:131], v[96:99], v[56:59], v[128:131]
    v_mfma_f32_16x16x32_bf16 v[144:147], v[96:99], v[60:63], v[144:147]
    v_mfma_f32_16x16x32_bf16 v[160:163], v[96:99], v[64:67], v[160:163]
    v_mfma_f32_16x16x32_bf16 v[176:179], v[96:99], v[68:71], v[176:179]
    s_waitcnt lgkmcnt(0)
    s_barrier
    v_mfma_f32_16x16x32_bf16 v[132:135], v[100:103], v[56:59], v[132:135]
    ds_read_b128 v[40:43], v2 offset:40960
    v_mfma_f32_16x16x32_bf16 v[148:151], v[100:103], v[60:63], v[148:151]
    ds_read_b64_tr_b16 v[72:73], v4 offset:40960
    v_mfma_f32_16x16x32_bf16 v[164:167], v[100:103], v[64:67], v[164:167]
    ds_read_b64_tr_b16 v[74:75], v4 offset:41472
    v_mfma_f32_16x16x32_bf16 v[180:183], v[100:103], v[68:71], v[180:183]
    ds_read_b128 v[44:47], v2 offset:43008
    v_mfma_f32_16x16x32_bf16 v[136:139], v[104:107], v[56:59], v[136:139]
    ds_read_b128 v[48:51], v2 offset:45056
    v_mfma_f32_16x16x32_bf16 v[152:155], v[104:107], v[60:63], v[152:155]
    ds_read_b128 v[52:55], v2 offset:47104
    v_mfma_f32_16x16x32_bf16 v[168:171], v[104:107], v[64:67], v[168:171]
    ds_read_b64_tr_b16 v[76:77], v5 offset:40960
    v_mfma_f32_16x16x32_bf16 v[184:187], v[104:107], v[68:71], v[184:187]
    ds_read_b64_tr_b16 v[78:79], v5 offset:41472
    v_mfma_f32_16x16x32_bf16 v[140:143], v[108:111], v[56:59], v[140:143]
    ds_read_b64_tr_b16 v[80:81], v4 offset:43008
    v_mfma_f32_16x16x32_bf16 v[156:159], v[108:111], v[60:63], v[156:159]
    ds_read_b64_tr_b16 v[82:83], v4 offset:43520
    v_mfma_f32_16x16x32_bf16 v[172:175], v[108:111], v[64:67], v[172:175]
    ds_read_b64_tr_b16 v[84:85], v5 offset:43008
    v_mfma_f32_16x16x32_bf16 v[188:191], v[108:111], v[68:71], v[188:191]
    ds_read_b64_tr_b16 v[86:87], v5 offset:43520
    v_mfma_f32_16x16x32_bf16 v[192:195], v[112:115], v[56:59], v[192:195]
    ds_read_b64_tr_b16 v[88:89], v4 offset:45056
    v_mfma_f32_16x16x32_bf16 v[200:203], v[112:115], v[60:63], v[200:203]
    ds_read_b64_tr_b16 v[90:91], v4 offset:45568
    v_mfma_f32_16x16x32_bf16 v[208:211], v[112:115], v[64:67], v[208:211]
    ds_read_b64_tr_b16 v[92:93], v5 offset:45056
    v_mfma_f32_16x16x32_bf16 v[216:219], v[112:115], v[68:71], v[216:219]
    ds_read_b64_tr_b16 v[94:95], v5 offset:45568
    v_mfma_f32_16x16x32_bf16 v[196:199], v[116:119], v[56:59], v[196:199]
    v_mfma_f32_16x16x32_bf16 v[204:207], v[116:119], v[60:63], v[204:207]
    v_mfma_f32_16x16x32_bf16 v[212:215], v[116:119], v[64:67], v[212:215]
    v_mfma_f32_16x16x32_bf16 v[220:223], v[116:119], v[68:71], v[220:223]
    s_waitcnt lgkmcnt(8)
    v_mfma_f32_16x16x32_bf16 v[128:131], v[72:75], v[40:43], v[128:131]
    ds_read_b128 v[56:59], v3 offset:40960
    v_mfma_f32_16x16x32_bf16 v[144:147], v[72:75], v[44:47], v[144:147]
    ds_read_b64_tr_b16 v[96:97], v4 offset:53248
    v_mfma_f32_16x16x32_bf16 v[160:163], v[72:75], v[48:51], v[160:163]
    ds_read_b64_tr_b16 v[98:99], v4 offset:53760
    v_mfma_f32_16x16x32_bf16 v[176:179], v[72:75], v[52:55], v[176:179]
    ds_read_b128 v[60:63], v3 offset:43008
    v_mfma_f32_16x16x32_bf16 v[132:135], v[76:79], v[40:43], v[132:135]
    ds_read_b128 v[64:67], v3 offset:45056
    v_mfma_f32_16x16x32_bf16 v[148:151], v[76:79], v[44:47], v[148:151]
    ds_read_b128 v[68:71], v3 offset:47104
    v_mfma_f32_16x16x32_bf16 v[164:167], v[76:79], v[48:51], v[164:167]
    ds_read_b64_tr_b16 v[100:101], v5 offset:53248
    v_mfma_f32_16x16x32_bf16 v[180:183], v[76:79], v[52:55], v[180:183]
    ds_read_b64_tr_b16 v[102:103], v5 offset:53760
    s_waitcnt lgkmcnt(8)
    v_mfma_f32_16x16x32_bf16 v[136:139], v[80:83], v[40:43], v[136:139]
    ds_read_b64_tr_b16 v[104:105], v4 offset:55296
    v_mfma_f32_16x16x32_bf16 v[152:155], v[80:83], v[44:47], v[152:155]
    ds_read_b64_tr_b16 v[106:107], v4 offset:55808
    v_mfma_f32_16x16x32_bf16 v[168:171], v[80:83], v[48:51], v[168:171]
    ds_read_b64_tr_b16 v[108:109], v5 offset:55296
    v_mfma_f32_16x16x32_bf16 v[184:187], v[80:83], v[52:55], v[184:187]
    ds_read_b64_tr_b16 v[110:111], v5 offset:55808
    v_mfma_f32_16x16x32_bf16 v[140:143], v[84:87], v[40:43], v[140:143]
    ds_read_b64_tr_b16 v[112:113], v4 offset:57344
    v_mfma_f32_16x16x32_bf16 v[156:159], v[84:87], v[44:47], v[156:159]
    ds_read_b64_tr_b16 v[114:115], v4 offset:57856
    v_mfma_f32_16x16x32_bf16 v[172:175], v[84:87], v[48:51], v[172:175]
    ds_read_b64_tr_b16 v[116:117], v5 offset:57344
    v_mfma_f32_16x16x32_bf16 v[188:191], v[84:87], v[52:55], v[188:191]
    ds_read_b64_tr_b16 v[118:119], v5 offset:57856
    v_mfma_f32_16x16x32_bf16 v[192:195], v[88:91], v[40:43], v[192:195]
    v_mfma_f32_16x16x32_bf16 v[200:203], v[88:91], v[44:47], v[200:203]
    v_mfma_f32_16x16x32_bf16 v[208:211], v[88:91], v[48:51], v[208:211]
    v_mfma_f32_16x16x32_bf16 v[216:219], v[88:91], v[52:55], v[216:219]
    v_mfma_f32_16x16x32_bf16 v[196:199], v[92:95], v[40:43], v[196:199]
    v_mfma_f32_16x16x32_bf16 v[204:207], v[92:95], v[44:47], v[204:207]
    v_mfma_f32_16x16x32_bf16 v[212:215], v[92:95], v[48:51], v[212:215]
    v_mfma_f32_16x16x32_bf16 v[220:223], v[92:95], v[52:55], v[220:223]
    s_waitcnt lgkmcnt(8)
    v_mfma_f32_16x16x32_bf16 v[128:131], v[96:99], v[56:59], v[128:131]
    v_mfma_f32_16x16x32_bf16 v[144:147], v[96:99], v[60:63], v[144:147]
    v_mfma_f32_16x16x32_bf16 v[160:163], v[96:99], v[64:67], v[160:163]
    v_mfma_f32_16x16x32_bf16 v[176:179], v[96:99], v[68:71], v[176:179]
    s_waitcnt lgkmcnt(0)
    s_barrier
    v_mfma_f32_16x16x32_bf16 v[132:135], v[100:103], v[56:59], v[132:135]
    v_add_u32 v4, 81920, v4
    v_add_u32 v5, 81920, v5
    v_mfma_f32_16x16x32_bf16 v[148:151], v[100:103], v[60:63], v[148:151]
    v_add_u32 v2, 81920, v2
    v_add_u32 v3, 81920, v3
    v_mfma_f32_16x16x32_bf16 v[164:167], v[100:103], v[64:67], v[164:167]
    ds_read_b128 v[40:43], v2 offset:0
    v_mfma_f32_16x16x32_bf16 v[180:183], v[100:103], v[68:71], v[180:183]
    ds_read_b64_tr_b16 v[72:73], v4 offset:0
    v_mfma_f32_16x16x32_bf16 v[136:139], v[104:107], v[56:59], v[136:139]
    ds_read_b64_tr_b16 v[74:75], v4 offset:512
    v_mfma_f32_16x16x32_bf16 v[152:155], v[104:107], v[60:63], v[152:155]
    ds_read_b128 v[44:47], v2 offset:2048
    v_mfma_f32_16x16x32_bf16 v[168:171], v[104:107], v[64:67], v[168:171]
    ds_read_b128 v[48:51], v2 offset:4096
    v_mfma_f32_16x16x32_bf16 v[184:187], v[104:107], v[68:71], v[184:187]
    ds_read_b128 v[52:55], v2 offset:6144
    v_mfma_f32_16x16x32_bf16 v[140:143], v[108:111], v[56:59], v[140:143]
    ds_read_b64_tr_b16 v[76:77], v5 offset:0
    v_mfma_f32_16x16x32_bf16 v[156:159], v[108:111], v[60:63], v[156:159]
    ds_read_b64_tr_b16 v[78:79], v5 offset:512
    v_mfma_f32_16x16x32_bf16 v[172:175], v[108:111], v[64:67], v[172:175]
    ds_read_b64_tr_b16 v[80:81], v4 offset:2048
    v_mfma_f32_16x16x32_bf16 v[188:191], v[108:111], v[68:71], v[188:191]
    ds_read_b64_tr_b16 v[82:83], v4 offset:2560
    v_mfma_f32_16x16x32_bf16 v[192:195], v[112:115], v[56:59], v[192:195]
    ds_read_b64_tr_b16 v[84:85], v5 offset:2048
    v_mfma_f32_16x16x32_bf16 v[200:203], v[112:115], v[60:63], v[200:203]
    ds_read_b64_tr_b16 v[86:87], v5 offset:2560
    v_mfma_f32_16x16x32_bf16 v[208:211], v[112:115], v[64:67], v[208:211]
    ds_read_b64_tr_b16 v[88:89], v4 offset:4096
    v_mfma_f32_16x16x32_bf16 v[216:219], v[112:115], v[68:71], v[216:219]
    ds_read_b64_tr_b16 v[90:91], v4 offset:4608
    v_mfma_f32_16x16x32_bf16 v[196:199], v[116:119], v[56:59], v[196:199]
    ds_read_b64_tr_b16 v[92:93], v5 offset:4096
    v_mfma_f32_16x16x32_bf16 v[204:207], v[116:119], v[60:63], v[204:207]
    ds_read_b64_tr_b16 v[94:95], v5 offset:4608
    v_mfma_f32_16x16x32_bf16 v[212:215], v[116:119], v[64:67], v[212:215]
    v_mfma_f32_16x16x32_bf16 v[220:223], v[116:119], v[68:71], v[220:223]
    s_waitcnt lgkmcnt(8)
    v_mfma_f32_16x16x32_bf16 v[128:131], v[72:75], v[40:43], v[128:131]
    ds_read_b128 v[56:59], v3 offset:0
    v_mfma_f32_16x16x32_bf16 v[144:147], v[72:75], v[44:47], v[144:147]
    ds_read_b64_tr_b16 v[96:97], v4 offset:12288
    v_mfma_f32_16x16x32_bf16 v[160:163], v[72:75], v[48:51], v[160:163]
    ds_read_b64_tr_b16 v[98:99], v4 offset:12800
    v_mfma_f32_16x16x32_bf16 v[176:179], v[72:75], v[52:55], v[176:179]
    ds_read_b128 v[60:63], v3 offset:2048
    v_mfma_f32_16x16x32_bf16 v[132:135], v[76:79], v[40:43], v[132:135]
    ds_read_b128 v[64:67], v3 offset:4096
    v_mfma_f32_16x16x32_bf16 v[148:151], v[76:79], v[44:47], v[148:151]
    ds_read_b128 v[68:71], v3 offset:6144
    v_mfma_f32_16x16x32_bf16 v[164:167], v[76:79], v[48:51], v[164:167]
    ds_read_b64_tr_b16 v[100:101], v5 offset:12288
    v_mfma_f32_16x16x32_bf16 v[180:183], v[76:79], v[52:55], v[180:183]
    ds_read_b64_tr_b16 v[102:103], v5 offset:12800
    s_waitcnt lgkmcnt(8)
    v_mfma_f32_16x16x32_bf16 v[136:139], v[80:83], v[40:43], v[136:139]
    ds_read_b64_tr_b16 v[104:105], v4 offset:14336
    v_mfma_f32_16x16x32_bf16 v[152:155], v[80:83], v[44:47], v[152:155]
    ds_read_b64_tr_b16 v[106:107], v4 offset:14848
    v_mfma_f32_16x16x32_bf16 v[168:171], v[80:83], v[48:51], v[168:171]
    ds_read_b64_tr_b16 v[108:109], v5 offset:14336
    v_mfma_f32_16x16x32_bf16 v[184:187], v[80:83], v[52:55], v[184:187]
    ds_read_b64_tr_b16 v[110:111], v5 offset:14848
    v_mfma_f32_16x16x32_bf16 v[140:143], v[84:87], v[40:43], v[140:143]
    ds_read_b64_tr_b16 v[112:113], v4 offset:16384
    v_mfma_f32_16x16x32_bf16 v[156:159], v[84:87], v[44:47], v[156:159]
    ds_read_b64_tr_b16 v[114:115], v4 offset:16896
    v_mfma_f32_16x16x32_bf16 v[172:175], v[84:87], v[48:51], v[172:175]
    ds_read_b64_tr_b16 v[116:117], v5 offset:16384
    v_mfma_f32_16x16x32_bf16 v[188:191], v[84:87], v[52:55], v[188:191]
    ds_read_b64_tr_b16 v[118:119], v5 offset:16896
    v_mfma_f32_16x16x32_bf16 v[192:195], v[88:91], v[40:43], v[192:195]
    v_mfma_f32_16x16x32_bf16 v[200:203], v[88:91], v[44:47], v[200:203]
    v_mfma_f32_16x16x32_bf16 v[208:211], v[88:91], v[48:51], v[208:211]
    v_mfma_f32_16x16x32_bf16 v[216:219], v[88:91], v[52:55], v[216:219]
    v_mfma_f32_16x16x32_bf16 v[196:199], v[92:95], v[40:43], v[196:199]
    v_mfma_f32_16x16x32_bf16 v[204:207], v[92:95], v[44:47], v[204:207]
    v_mfma_f32_16x16x32_bf16 v[212:215], v[92:95], v[48:51], v[212:215]
    v_mfma_f32_16x16x32_bf16 v[220:223], v[92:95], v[52:55], v[220:223]
    s_waitcnt lgkmcnt(8)
    v_mfma_f32_16x16x32_bf16 v[128:131], v[96:99], v[56:59], v[128:131]
    v_mfma_f32_16x16x32_bf16 v[144:147], v[96:99], v[60:63], v[144:147]
    v_mfma_f32_16x16x32_bf16 v[160:163], v[96:99], v[64:67], v[160:163]
    v_mfma_f32_16x16x32_bf16 v[176:179], v[96:99], v[68:71], v[176:179]
    s_waitcnt lgkmcnt(0)
    s_barrier
    v_mfma_f32_16x16x32_bf16 v[132:135], v[100:103], v[56:59], v[132:135]
    v_subrev_u32 v4, 81920, v4
    v_subrev_u32 v5, 81920, v5
    v_mfma_f32_16x16x32_bf16 v[148:151], v[100:103], v[60:63], v[148:151]
    v_subrev_u32 v2, 81920, v2
    v_subrev_u32 v3, 81920, v3
    v_mfma_f32_16x16x32_bf16 v[164:167], v[100:103], v[64:67], v[164:167]
    ds_read_b128 v[40:43], v2 offset:0
    v_mfma_f32_16x16x32_bf16 v[180:183], v[100:103], v[68:71], v[180:183]
    ds_read_b64_tr_b16 v[72:73], v4 offset:0
    v_mfma_f32_16x16x32_bf16 v[136:139], v[104:107], v[56:59], v[136:139]
    ds_read_b64_tr_b16 v[74:75], v4 offset:512
    v_mfma_f32_16x16x32_bf16 v[152:155], v[104:107], v[60:63], v[152:155]
    ds_read_b128 v[44:47], v2 offset:2048
    v_mfma_f32_16x16x32_bf16 v[168:171], v[104:107], v[64:67], v[168:171]
    ds_read_b128 v[48:51], v2 offset:4096
    v_mfma_f32_16x16x32_bf16 v[184:187], v[104:107], v[68:71], v[184:187]
    ds_read_b128 v[52:55], v2 offset:6144
    v_mfma_f32_16x16x32_bf16 v[140:143], v[108:111], v[56:59], v[140:143]
    ds_read_b64_tr_b16 v[76:77], v5 offset:0
    v_mfma_f32_16x16x32_bf16 v[156:159], v[108:111], v[60:63], v[156:159]
    ds_read_b64_tr_b16 v[78:79], v5 offset:512
    v_mfma_f32_16x16x32_bf16 v[172:175], v[108:111], v[64:67], v[172:175]
    ds_read_b64_tr_b16 v[80:81], v4 offset:2048
    v_mfma_f32_16x16x32_bf16 v[188:191], v[108:111], v[68:71], v[188:191]
    ds_read_b64_tr_b16 v[82:83], v4 offset:2560
    v_mfma_f32_16x16x32_bf16 v[192:195], v[112:115], v[56:59], v[192:195]
    ds_read_b64_tr_b16 v[84:85], v5 offset:2048
    v_mfma_f32_16x16x32_bf16 v[200:203], v[112:115], v[60:63], v[200:203]
    ds_read_b64_tr_b16 v[86:87], v5 offset:2560
    v_mfma_f32_16x16x32_bf16 v[208:211], v[112:115], v[64:67], v[208:211]
    ds_read_b64_tr_b16 v[88:89], v4 offset:4096
    v_mfma_f32_16x16x32_bf16 v[216:219], v[112:115], v[68:71], v[216:219]
    ds_read_b64_tr_b16 v[90:91], v4 offset:4608
    v_mfma_f32_16x16x32_bf16 v[196:199], v[116:119], v[56:59], v[196:199]
    ds_read_b64_tr_b16 v[92:93], v5 offset:4096
    v_mfma_f32_16x16x32_bf16 v[204:207], v[116:119], v[60:63], v[204:207]
    ds_read_b64_tr_b16 v[94:95], v5 offset:4608
    v_mfma_f32_16x16x32_bf16 v[212:215], v[116:119], v[64:67], v[212:215]
    v_mfma_f32_16x16x32_bf16 v[220:223], v[116:119], v[68:71], v[220:223]
    s_waitcnt lgkmcnt(8)
    v_mfma_f32_16x16x32_bf16 v[128:131], v[72:75], v[40:43], v[128:131]
    ds_read_b128 v[56:59], v3 offset:0
    v_mfma_f32_16x16x32_bf16 v[144:147], v[72:75], v[44:47], v[144:147]
    ds_read_b64_tr_b16 v[96:97], v4 offset:12288
    v_mfma_f32_16x16x32_bf16 v[160:163], v[72:75], v[48:51], v[160:163]
    ds_read_b64_tr_b16 v[98:99], v4 offset:12800
    v_mfma_f32_16x16x32_bf16 v[176:179], v[72:75], v[52:55], v[176:179]
    ds_read_b128 v[60:63], v3 offset:2048
    v_mfma_f32_16x16x32_bf16 v[132:135], v[76:79], v[40:43], v[132:135]
    ds_read_b128 v[64:67], v3 offset:4096
    v_mfma_f32_16x16x32_bf16 v[148:151], v[76:79], v[44:47], v[148:151]
    ds_read_b128 v[68:71], v3 offset:6144
    v_mfma_f32_16x16x32_bf16 v[164:167], v[76:79], v[48:51], v[164:167]
    ds_read_b64_tr_b16 v[100:101], v5 offset:12288
    v_mfma_f32_16x16x32_bf16 v[180:183], v[76:79], v[52:55], v[180:183]
    ds_read_b64_tr_b16 v[102:103], v5 offset:12800
    s_waitcnt lgkmcnt(8)
    v_mfma_f32_16x16x32_bf16 v[136:139], v[80:83], v[40:43], v[136:139]
    ds_read_b64_tr_b16 v[104:105], v4 offset:14336
    v_mfma_f32_16x16x32_bf16 v[152:155], v[80:83], v[44:47], v[152:155]
    ds_read_b64_tr_b16 v[106:107], v4 offset:14848
    v_mfma_f32_16x16x32_bf16 v[168:171], v[80:83], v[48:51], v[168:171]
    ds_read_b64_tr_b16 v[108:109], v5 offset:14336
    v_mfma_f32_16x16x32_bf16 v[184:187], v[80:83], v[52:55], v[184:187]
    ds_read_b64_tr_b16 v[110:111], v5 offset:14848
    v_mfma_f32_16x16x32_bf16 v[140:143], v[84:87], v[40:43], v[140:143]
    ds_read_b64_tr_b16 v[112:113], v4 offset:16384
    v_mfma_f32_16x16x32_bf16 v[156:159], v[84:87], v[44:47], v[156:159]
    ds_read_b64_tr_b16 v[114:115], v4 offset:16896
    v_mfma_f32_16x16x32_bf16 v[172:175], v[84:87], v[48:51], v[172:175]
    ds_read_b64_tr_b16 v[116:117], v5 offset:16384
    v_mfma_f32_16x16x32_bf16 v[188:191], v[84:87], v[52:55], v[188:191]
    ds_read_b64_tr_b16 v[118:119], v5 offset:16896
    v_mfma_f32_16x16x32_bf16 v[192:195], v[88:91], v[40:43], v[192:195]
    v_mfma_f32_16x16x32_bf16 v[200:203], v[88:91], v[44:47], v[200:203]
    v_mfma_f32_16x16x32_bf16 v[208:211], v[88:91], v[48:51], v[208:211]
    v_mfma_f32_16x16x32_bf16 v[216:219], v[88:91], v[52:55], v[216:219]
    v_mfma_f32_16x16x32_bf16 v[196:199], v[92:95], v[40:43], v[196:199]
    v_mfma_f32_16x16x32_bf16 v[204:207], v[92:95], v[44:47], v[204:207]
    v_mfma_f32_16x16x32_bf16 v[212:215], v[92:95], v[48:51], v[212:215]
    v_mfma_f32_16x16x32_bf16 v[220:223], v[92:95], v[52:55], v[220:223]
    ds_read_b64_tr_b16 v[224:225], v121 offset:0
    ds_read_b64_tr_b16 v[226:227], v121 offset:512
    ds_read_b64_tr_b16 v[228:229], v121 offset:2048
    ds_read_b64_tr_b16 v[230:231], v121 offset:2560
    s_waitcnt lgkmcnt(12)
    v_mfma_f32_16x16x32_bf16 v[128:131], v[96:99], v[56:59], v[128:131]
    v_mfma_f32_16x16x32_bf16 v[144:147], v[96:99], v[60:63], v[144:147]
    v_mfma_f32_16x16x32_bf16 v[160:163], v[96:99], v[64:67], v[160:163]
    v_mfma_f32_16x16x32_bf16 v[176:179], v[96:99], v[68:71], v[176:179]
    s_waitcnt lgkmcnt(0)
    s_barrier
    v_mfma_f32_16x16x32_bf16 v[132:135], v[100:103], v[56:59], v[132:135]
    ds_read_b128 v[40:43], v2 offset:40960
    v_mfma_f32_16x16x32_bf16 v[148:151], v[100:103], v[60:63], v[148:151]
    ds_read_b64_tr_b16 v[72:73], v4 offset:40960
    v_mfma_f32_16x16x32_bf16 v[164:167], v[100:103], v[64:67], v[164:167]
    ds_read_b64_tr_b16 v[74:75], v4 offset:41472
    v_mfma_f32_16x16x32_bf16 v[180:183], v[100:103], v[68:71], v[180:183]
    ds_read_b128 v[44:47], v2 offset:43008
    v_mfma_f32_16x16x32_bf16 v[136:139], v[104:107], v[56:59], v[136:139]
    ds_read_b128 v[48:51], v2 offset:45056
    v_mfma_f32_16x16x32_bf16 v[152:155], v[104:107], v[60:63], v[152:155]
    ds_read_b128 v[52:55], v2 offset:47104
    v_mfma_f32_16x16x32_bf16 v[168:171], v[104:107], v[64:67], v[168:171]
    ds_read_b64_tr_b16 v[76:77], v5 offset:40960
    v_mfma_f32_16x16x32_bf16 v[184:187], v[104:107], v[68:71], v[184:187]
    ds_read_b64_tr_b16 v[78:79], v5 offset:41472
    v_mfma_f32_16x16x32_bf16 v[140:143], v[108:111], v[56:59], v[140:143]
    ds_read_b64_tr_b16 v[80:81], v4 offset:43008
    v_mfma_f32_16x16x32_bf16 v[156:159], v[108:111], v[60:63], v[156:159]
    ds_read_b64_tr_b16 v[82:83], v4 offset:43520
    v_mfma_f32_16x16x32_bf16 v[172:175], v[108:111], v[64:67], v[172:175]
    ds_read_b64_tr_b16 v[84:85], v5 offset:43008
    v_mfma_f32_16x16x32_bf16 v[188:191], v[108:111], v[68:71], v[188:191]
    ds_read_b64_tr_b16 v[86:87], v5 offset:43520
    v_mfma_f32_16x16x32_bf16 v[192:195], v[112:115], v[56:59], v[192:195]
    ds_read_b64_tr_b16 v[88:89], v4 offset:45056
    v_mfma_f32_16x16x32_bf16 v[200:203], v[112:115], v[60:63], v[200:203]
    ds_read_b64_tr_b16 v[90:91], v4 offset:45568
    v_mfma_f32_16x16x32_bf16 v[208:211], v[112:115], v[64:67], v[208:211]
    ds_read_b64_tr_b16 v[92:93], v5 offset:45056
    v_mfma_f32_16x16x32_bf16 v[216:219], v[112:115], v[68:71], v[216:219]
    ds_read_b64_tr_b16 v[94:95], v5 offset:45568
    v_mfma_f32_16x16x32_bf16 v[196:199], v[116:119], v[56:59], v[196:199]
    v_mfma_f32_16x16x32_bf16 v[204:207], v[116:119], v[60:63], v[204:207]
    v_mfma_f32_16x16x32_bf16 v[212:215], v[116:119], v[64:67], v[212:215]
    v_mfma_f32_16x16x32_bf16 v[220:223], v[116:119], v[68:71], v[220:223]
    v_mfma_f32_16x16x32_bf16 v[24:27], v[20:23], v[224:227], 0
    v_mfma_f32_16x16x32_bf16 v[28:31], v[20:23], v[228:231], 0
    s_waitcnt lgkmcnt(8)
    v_mfma_f32_16x16x32_bf16 v[128:131], v[72:75], v[40:43], v[128:131]
    ds_read_b128 v[56:59], v3 offset:40960
    v_mfma_f32_16x16x32_bf16 v[144:147], v[72:75], v[44:47], v[144:147]
    ds_read_b64_tr_b16 v[96:97], v4 offset:53248
    v_mfma_f32_16x16x32_bf16 v[160:163], v[72:75], v[48:51], v[160:163]
    ds_read_b64_tr_b16 v[98:99], v4 offset:53760
    v_mfma_f32_16x16x32_bf16 v[176:179], v[72:75], v[52:55], v[176:179]
    ds_read_b128 v[60:63], v3 offset:43008
    v_mfma_f32_16x16x32_bf16 v[132:135], v[76:79], v[40:43], v[132:135]
    ds_read_b128 v[64:67], v3 offset:45056
    v_mfma_f32_16x16x32_bf16 v[148:151], v[76:79], v[44:47], v[148:151]
    ds_read_b128 v[68:71], v3 offset:47104
    v_mfma_f32_16x16x32_bf16 v[164:167], v[76:79], v[48:51], v[164:167]
    ds_read_b64_tr_b16 v[100:101], v5 offset:53248
    v_mfma_f32_16x16x32_bf16 v[180:183], v[76:79], v[52:55], v[180:183]
    ds_read_b64_tr_b16 v[102:103], v5 offset:53760
    s_waitcnt lgkmcnt(8)
    v_mfma_f32_16x16x32_bf16 v[136:139], v[80:83], v[40:43], v[136:139]
    ds_read_b64_tr_b16 v[104:105], v4 offset:55296
    v_mfma_f32_16x16x32_bf16 v[152:155], v[80:83], v[44:47], v[152:155]
    ds_read_b64_tr_b16 v[106:107], v4 offset:55808
    v_mfma_f32_16x16x32_bf16 v[168:171], v[80:83], v[48:51], v[168:171]
    ds_read_b64_tr_b16 v[108:109], v5 offset:55296
    v_mfma_f32_16x16x32_bf16 v[184:187], v[80:83], v[52:55], v[184:187]
    ds_read_b64_tr_b16 v[110:111], v5 offset:55808
    v_mfma_f32_16x16x32_bf16 v[140:143], v[84:87], v[40:43], v[140:143]
    ds_read_b64_tr_b16 v[112:113], v4 offset:57344
    v_mfma_f32_16x16x32_bf16 v[156:159], v[84:87], v[44:47], v[156:159]
    ds_read_b64_tr_b16 v[114:115], v4 offset:57856
    v_mfma_f32_16x16x32_bf16 v[172:175], v[84:87], v[48:51], v[172:175]
    ds_read_b64_tr_b16 v[116:117], v5 offset:57344
    v_mfma_f32_16x16x32_bf16 v[188:191], v[84:87], v[52:55], v[188:191]
    ds_read_b64_tr_b16 v[118:119], v5 offset:57856
    v_mfma_f32_16x16x32_bf16 v[192:195], v[88:91], v[40:43], v[192:195]
    v_mfma_f32_16x16x32_bf16 v[200:203], v[88:91], v[44:47], v[200:203]
    v_mfma_f32_16x16x32_bf16 v[208:211], v[88:91], v[48:51], v[208:211]
    v_mfma_f32_16x16x32_bf16 v[216:219], v[88:91], v[52:55], v[216:219]
    v_mfma_f32_16x16x32_bf16 v[196:199], v[92:95], v[40:43], v[196:199]
    v_mfma_f32_16x16x32_bf16 v[204:207], v[92:95], v[44:47], v[204:207]
    v_mfma_f32_16x16x32_bf16 v[212:215], v[92:95], v[48:51], v[212:215]
    v_mfma_f32_16x16x32_bf16 v[220:223], v[92:95], v[52:55], v[220:223]
    s_mov_b64 exec, s[94:95]
    s_add_u32 s63, s90, 12288
    buffer_store_dword v24, v122, s[24:27], s63 offen sc1
    s_add_u32 s63, s90, 16384
    buffer_store_dword v28, v122, s[24:27], s63 offen sc1
    s_mov_b64 exec, -1
    s_waitcnt lgkmcnt(8)
    v_mfma_f32_16x16x32_bf16 v[128:131], v[96:99], v[56:59], v[128:131]
    v_mfma_f32_16x16x32_bf16 v[144:147], v[96:99], v[60:63], v[144:147]
    v_mfma_f32_16x16x32_bf16 v[160:163], v[96:99], v[64:67], v[160:163]
    v_mfma_f32_16x16x32_bf16 v[176:179], v[96:99], v[68:71], v[176:179]
    s_waitcnt vmcnt(0)
    s_waitcnt lgkmcnt(0)
    s_barrier
    v_mfma_f32_16x16x32_bf16 v[132:135], v[100:103], v[56:59], v[132:135]
    v_add_u32 v4, 81920, v4
    v_add_u32 v5, 81920, v5
    v_mfma_f32_16x16x32_bf16 v[148:151], v[100:103], v[60:63], v[148:151]
    v_add_u32 v2, 81920, v2
    v_add_u32 v3, 81920, v3
    v_mfma_f32_16x16x32_bf16 v[164:167], v[100:103], v[64:67], v[164:167]
    ds_read_b128 v[40:43], v2 offset:0
    v_mfma_f32_16x16x32_bf16 v[180:183], v[100:103], v[68:71], v[180:183]
    ds_read_b64_tr_b16 v[72:73], v4 offset:0
    v_mfma_f32_16x16x32_bf16 v[136:139], v[104:107], v[56:59], v[136:139]
    ds_read_b64_tr_b16 v[74:75], v4 offset:512
    v_mfma_f32_16x16x32_bf16 v[152:155], v[104:107], v[60:63], v[152:155]
    ds_read_b128 v[44:47], v2 offset:2048
    v_mfma_f32_16x16x32_bf16 v[168:171], v[104:107], v[64:67], v[168:171]
    ds_read_b128 v[48:51], v2 offset:4096
    v_mfma_f32_16x16x32_bf16 v[184:187], v[104:107], v[68:71], v[184:187]
    ds_read_b128 v[52:55], v2 offset:6144
    v_mfma_f32_16x16x32_bf16 v[140:143], v[108:111], v[56:59], v[140:143]
    ds_read_b64_tr_b16 v[76:77], v5 offset:0
    v_mfma_f32_16x16x32_bf16 v[156:159], v[108:111], v[60:63], v[156:159]
    ds_read_b64_tr_b16 v[78:79], v5 offset:512
    v_mfma_f32_16x16x32_bf16 v[172:175], v[108:111], v[64:67], v[172:175]
    ds_read_b64_tr_b16 v[80:81], v4 offset:2048
    v_mfma_f32_16x16x32_bf16 v[188:191], v[108:111], v[68:71], v[188:191]
    ds_read_b64_tr_b16 v[82:83], v4 offset:2560
    v_mfma_f32_16x16x32_bf16 v[192:195], v[112:115], v[56:59], v[192:195]
    ds_read_b64_tr_b16 v[84:85], v5 offset:2048
    v_mfma_f32_16x16x32_bf16 v[200:203], v[112:115], v[60:63], v[200:203]
    ds_read_b64_tr_b16 v[86:87], v5 offset:2560
    v_mfma_f32_16x16x32_bf16 v[208:211], v[112:115], v[64:67], v[208:211]
    ds_read_b64_tr_b16 v[88:89], v4 offset:4096
    v_mfma_f32_16x16x32_bf16 v[216:219], v[112:115], v[68:71], v[216:219]
    ds_read_b64_tr_b16 v[90:91], v4 offset:4608
    v_mfma_f32_16x16x32_bf16 v[196:199], v[116:119], v[56:59], v[196:199]
    ds_read_b64_tr_b16 v[92:93], v5 offset:4096
    v_mfma_f32_16x16x32_bf16 v[204:207], v[116:119], v[60:63], v[204:207]
    ds_read_b64_tr_b16 v[94:95], v5 offset:4608
    v_mfma_f32_16x16x32_bf16 v[212:215], v[116:119], v[64:67], v[212:215]
    v_mfma_f32_16x16x32_bf16 v[220:223], v[116:119], v[68:71], v[220:223]
    v_mov_b32 v15, 19005440
    s_mov_b64 exec, 1
    buffer_store_dwordx4 v[36:39], v15, s[24:27], s72 offen sc1
    s_mov_b64 exec, -1
    s_waitcnt lgkmcnt(8)
    v_mfma_f32_16x16x32_bf16 v[128:131], v[72:75], v[40:43], v[128:131]
    ds_read_b128 v[56:59], v3 offset:0
    v_mfma_f32_16x16x32_bf16 v[144:147], v[72:75], v[44:47], v[144:147]
    ds_read_b64_tr_b16 v[96:97], v4 offset:12288
    v_mfma_f32_16x16x32_bf16 v[160:163], v[72:75], v[48:51], v[160:163]
    ds_read_b64_tr_b16 v[98:99], v4 offset:12800
    v_mfma_f32_16x16x32_bf16 v[176:179], v[72:75], v[52:55], v[176:179]
    ds_read_b128 v[60:63], v3 offset:2048
    v_mfma_f32_16x16x32_bf16 v[132:135], v[76:79], v[40:43], v[132:135]
    ds_read_b128 v[64:67], v3 offset:4096
    v_mfma_f32_16x16x32_bf16 v[148:151], v[76:79], v[44:47], v[148:151]
    ds_read_b128 v[68:71], v3 offset:6144
    v_mfma_f32_16x16x32_bf16 v[164:167], v[76:79], v[48:51], v[164:167]
    ds_read_b64_tr_b16 v[100:101], v5 offset:12288
    v_mfma_f32_16x16x32_bf16 v[180:183], v[76:79], v[52:55], v[180:183]
    ds_read_b64_tr_b16 v[102:103], v5 offset:12800
    s_waitcnt lgkmcnt(8)
    v_mfma_f32_16x16x32_bf16 v[136:139], v[80:83], v[40:43], v[136:139]
    ds_read_b64_tr_b16 v[104:105], v4 offset:14336
    v_mfma_f32_16x16x32_bf16 v[152:155], v[80:83], v[44:47], v[152:155]
    ds_read_b64_tr_b16 v[106:107], v4 offset:14848
    v_mfma_f32_16x16x32_bf16 v[168:171], v[80:83], v[48:51], v[168:171]
    ds_read_b64_tr_b16 v[108:109], v5 offset:14336
    v_mfma_f32_16x16x32_bf16 v[184:187], v[80:83], v[52:55], v[184:187]
    ds_read_b64_tr_b16 v[110:111], v5 offset:14848
    v_mfma_f32_16x16x32_bf16 v[140:143], v[84:87], v[40:43], v[140:143]
    ds_read_b64_tr_b16 v[112:113], v4 offset:16384
    v_mfma_f32_16x16x32_bf16 v[156:159], v[84:87], v[44:47], v[156:159]
    ds_read_b64_tr_b16 v[114:115], v4 offset:16896
    v_mfma_f32_16x16x32_bf16 v[172:175], v[84:87], v[48:51], v[172:175]
    ds_read_b64_tr_b16 v[116:117], v5 offset:16384
    v_mfma_f32_16x16x32_bf16 v[188:191], v[84:87], v[52:55], v[188:191]
    ds_read_b64_tr_b16 v[118:119], v5 offset:16896
    v_mfma_f32_16x16x32_bf16 v[192:195], v[88:91], v[40:43], v[192:195]
    v_add_u32 v16, 157696, v14
    v_mfma_f32_16x16x32_bf16 v[200:203], v[88:91], v[44:47], v[200:203]
    ds_read2_b32 v[224:225], v16 offset0:0 offset1:32
    v_mfma_f32_16x16x32_bf16 v[208:211], v[88:91], v[48:51], v[208:211]
    ds_read2_b32 v[226:227], v16 offset0:64 offset1:96
    v_mfma_f32_16x16x32_bf16 v[216:219], v[88:91], v[52:55], v[216:219]
    ds_read2_b32 v[228:229], v16 offset0:128 offset1:160
    v_mfma_f32_16x16x32_bf16 v[196:199], v[92:95], v[40:43], v[196:199]
    ds_read2_b32 v[230:231], v16 offset0:192 offset1:224
    v_mfma_f32_16x16x32_bf16 v[204:207], v[92:95], v[44:47], v[204:207]
    v_add_u32 v16, 32768, v14
    v_mfma_f32_16x16x32_bf16 v[212:215], v[92:95], v[48:51], v[212:215]
    ds_read2_b32 v[232:233], v16 offset0:0 offset1:32
    v_mfma_f32_16x16x32_bf16 v[220:223], v[92:95], v[52:55], v[220:223]
    ds_read2_b32 v[234:235], v16 offset0:64 offset1:96
    s_waitcnt lgkmcnt(14)
    v_mfma_f32_16x16x32_bf16 v[128:131], v[96:99], v[56:59], v[128:131]
    ds_read2_b32 v[236:237], v16 offset0:128 offset1:160
    v_mfma_f32_16x16x32_bf16 v[144:147], v[96:99], v[60:63], v[144:147]
    ds_read2_b32 v[238:239], v16 offset0:192 offset1:224
    v_mfma_f32_16x16x32_bf16 v[160:163], v[96:99], v[64:67], v[160:163]
    v_add_u32 v16, 36864, v14
    v_mfma_f32_16x16x32_bf16 v[176:179], v[96:99], v[68:71], v[176:179]
    ds_read2_b32 v[240:241], v16 offset0:0 offset1:32
    v_mfma_f32_16x16x32_bf16 v[132:135], v[100:103], v[56:59], v[132:135]
    ds_read2_b32 v[242:243], v16 offset0:64 offset1:96
    v_mfma_f32_16x16x32_bf16 v[148:151], v[100:103], v[60:63], v[148:151]
    ds_read2_b32 v[244:245], v16 offset0:128 offset1:160
    v_mfma_f32_16x16x32_bf16 v[164:167], v[100:103], v[64:67], v[164:167]
    ds_read2_b32 v[246:247], v16 offset0:192 offset1:224
    v_mfma_f32_16x16x32_bf16 v[180:183], v[100:103], v[68:71], v[180:183]
    ds_read_b128 v[20:23], v13 offset:0
    s_waitcnt lgkmcnt(13)
    v_mfma_f32_16x16x32_bf16 v[136:139], v[104:107], v[56:59], v[136:139]
    ds_read_b128 v[24:27], v13 offset:256
    v_mfma_f32_16x16x32_bf16 v[152:155], v[104:107], v[60:63], v[152:155]
    ds_read_b128 v[28:31], v13 offset:512
    v_mfma_f32_16x16x32_bf16 v[168:171], v[104:107], v[64:67], v[168:171]
    ds_read_b128 v[32:35], v13 offset:768
    v_mfma_f32_16x16x32_bf16 v[184:187], v[104:107], v[68:71], v[184:187]
    s_waitcnt lgkmcnt(12)
    v_add_f32 v224, v224, v225
    v_mfma_f32_16x16x32_bf16 v[140:143], v[108:111], v[56:59], v[140:143]
    v_add_f32 v226, v226, v227
    v_add_f32 v228, v228, v229
    v_mfma_f32_16x16x32_bf16 v[156:159], v[108:111], v[60:63], v[156:159]
    v_add_f32 v230, v230, v231
    v_add_f32 v224, v224, v226
    v_mfma_f32_16x16x32_bf16 v[172:175], v[108:111], v[64:67], v[172:175]
    v_add_f32 v228, v228, v230
    v_add_f32 v224, v224, v228
    v_mfma_f32_16x16x32_bf16 v[188:191], v[108:111], v[68:71], v[188:191]
    v_mov_b32 v225, v224
    s_waitcnt lgkmcnt(0)
    s_barrier
    v_mfma_f32_16x16x32_bf16 v[192:195], v[112:115], v[56:59], v[192:195]
    s_nop 1
    v_mfma_f32_16x16x32_bf16 v[200:203], v[112:115], v[60:63], v[200:203]
    v_permlane32_swap_b32 v224, v225
    v_mfma_f32_16x16x32_bf16 v[208:211], v[112:115], v[64:67], v[208:211]
    v_add_f32 v224, v224, v225
    v_cvt_pk_bf16_f32 v225, v224, v224
    v_mfma_f32_16x16x32_bf16 v[216:219], v[112:115], v[68:71], v[216:219]
    v_and_b32 v225, 0xffff0000, v225
    v_sub_f32 v224, v224, v225
    v_mfma_f32_16x16x32_bf16 v[196:199], v[116:119], v[56:59], v[196:199]
    v_cvt_pk_bf16_f32 v224, v225, v224
    v_cndmask_b32 v226, 0, v224, s[94:95]
    v_mfma_f32_16x16x32_bf16 v[204:207], v[116:119], v[60:63], v[204:207]
    v_cndmask_b32 v228, 0, v224, s[96:97]
    v_mov_b32 v227, v226
    v_mfma_f32_16x16x32_bf16 v[212:215], v[116:119], v[64:67], v[212:215]
    v_mov_b32 v229, v228
    v_mfma_f32_16x16x32_bf16 v[220:223], v[116:119], v[68:71], v[220:223]
    v_add_f32 v232, v232, v233
    v_add_f32 v234, v234, v235
    v_add_f32 v236, v236, v237
    v_add_f32 v238, v238, v239
    v_add_f32 v232, v232, v234
    v_add_f32 v236, v236, v238
    v_add_f32 v232, v232, v236
    v_mov_b32 v233, v232
    s_nop 1
    v_permlane32_swap_b32 v232, v233
    v_add_f32 v232, v232, v233
    v_cvt_pk_bf16_f32 v233, v232, v232
    v_and_b32 v233, 0xffff0000, v233
    v_sub_f32 v232, v232, v233
    v_cvt_pk_bf16_f32 v232, v233, v232
    v_cndmask_b32 v234, 0, v232, s[94:95]
    v_cndmask_b32 v236, 0, v232, s[96:97]
    v_mov_b32 v235, v234
    v_mov_b32 v237, v236
    v_add_f32 v240, v240, v241
    v_add_f32 v242, v242, v243
    v_add_f32 v244, v244, v245
    v_add_f32 v246, v246, v247
    v_add_f32 v240, v240, v242
    v_add_f32 v244, v244, v246
    v_add_f32 v240, v240, v244
    v_mov_b32 v241, v240
    s_nop 1
    v_permlane32_swap_b32 v240, v241
    v_add_f32 v240, v240, v241
    v_cvt_pk_bf16_f32 v241, v240, v240
    v_and_b32 v241, 0xffff0000, v241
    v_sub_f32 v240, v240, v241
    v_cvt_pk_bf16_f32 v240, v241, v240
    v_cndmask_b32 v242, 0, v240, s[94:95]
    v_cndmask_b32 v244, 0, v240, s[96:97]
    v_mov_b32 v243, v242
    v_mov_b32 v245, v244
    s_nop 1
    v_mfma_f32_16x16x16_bf16 v[192:195], v[226:227], v[20:21], v[192:195]
    v_mfma_f32_16x16x16_bf16 v[200:203], v[226:227], v[24:25], v[200:203]
    v_mfma_f32_16x16x16_bf16 v[208:211], v[226:227], v[28:29], v[208:211]
    v_mfma_f32_16x16x16_bf16 v[216:219], v[226:227], v[32:33], v[216:219]
    v_mfma_f32_16x16x16_bf16 v[196:199], v[228:229], v[20:21], v[196:199]
    v_mfma_f32_16x16x16_bf16 v[204:207], v[228:229], v[24:25], v[204:207]
    v_mfma_f32_16x16x16_bf16 v[212:215], v[228:229], v[28:29], v[212:215]
    v_mfma_f32_16x16x16_bf16 v[220:223], v[228:229], v[32:33], v[220:223]
    v_mfma_f32_16x16x16_bf16 v[128:131], v[234:235], v[20:21], v[128:131]
    v_mul_f32 v120, 0xbfb8aa3b, v22
    v_mfma_f32_16x16x16_bf16 v[144:147], v[234:235], v[24:25], v[144:147]
    v_mul_f32 v122, 0xbfb8aa3b, v26
    v_mfma_f32_16x16x16_bf16 v[160:163], v[234:235], v[28:29], v[160:163]
    v_mul_f32 v124, 0xbfb8aa3b, v30
    v_mfma_f32_16x16x16_bf16 v[176:179], v[234:235], v[32:33], v[176:179]
    v_mul_f32 v126, 0xbfb8aa3b, v34
    v_mfma_f32_16x16x16_bf16 v[132:135], v[236:237], v[20:21], v[132:135]
    v_mul_f32 v192, v192, v22
    v_mul_f32 v193, v193, v22
    v_mul_f32 v194, v194, v22
    v_mfma_f32_16x16x16_bf16 v[148:151], v[236:237], v[24:25], v[148:151]
    v_mul_f32 v195, v195, v22
    v_mul_f32 v196, v196, v22
    v_mul_f32 v197, v197, v22
    v_mfma_f32_16x16x16_bf16 v[164:167], v[236:237], v[28:29], v[164:167]
    v_mul_f32 v198, v198, v22
    v_mul_f32 v199, v199, v22
    v_mul_f32 v200, v200, v26
    v_mfma_f32_16x16x16_bf16 v[180:183], v[236:237], v[32:33], v[180:183]
    v_mul_f32 v201, v201, v26
    v_mul_f32 v202, v202, v26
    v_mul_f32 v203, v203, v26
    v_mfma_f32_16x16x16_bf16 v[136:139], v[242:243], v[20:21], v[136:139]
    v_mul_f32 v204, v204, v26
    v_mul_f32 v205, v205, v26
    v_mul_f32 v206, v206, v26
    v_mfma_f32_16x16x16_bf16 v[152:155], v[242:243], v[24:25], v[152:155]
    v_mul_f32 v207, v207, v26
    v_mul_f32 v208, v208, v30
    v_mul_f32 v209, v209, v30
    v_mfma_f32_16x16x16_bf16 v[168:171], v[242:243], v[28:29], v[168:171]
    v_mul_f32 v210, v210, v30
    v_mul_f32 v211, v211, v30
    v_mul_f32 v212, v212, v30
    v_mfma_f32_16x16x16_bf16 v[184:187], v[242:243], v[32:33], v[184:187]
    v_mul_f32 v213, v213, v30
    v_mul_f32 v214, v214, v30
    v_mul_f32 v215, v215, v30
    v_mfma_f32_16x16x16_bf16 v[140:143], v[244:245], v[20:21], v[140:143]
    v_mul_f32 v216, v216, v34
    v_mul_f32 v217, v217, v34
    v_mul_f32 v218, v218, v34
    v_mfma_f32_16x16x16_bf16 v[156:159], v[244:245], v[24:25], v[156:159]
    v_mul_f32 v219, v219, v34
    v_mul_f32 v220, v220, v34
    v_mul_f32 v221, v221, v34
    v_mfma_f32_16x16x16_bf16 v[172:175], v[244:245], v[28:29], v[172:175]
    v_mul_f32 v222, v222, v34
    v_mul_f32 v223, v223, v34
    v_mfma_f32_16x16x16_bf16 v[188:191], v[244:245], v[32:33], v[188:191]
    v_cvt_pk_bf16_f32 v192, v192, v193
    v_cvt_pk_bf16_f32 v193, v194, v195
    v_cvt_pk_bf16_f32 v194, v196, v197
    v_cvt_pk_bf16_f32 v195, v198, v199
    v_cvt_pk_bf16_f32 v200, v200, v201
    v_cvt_pk_bf16_f32 v201, v202, v203
    v_cvt_pk_bf16_f32 v202, v204, v205
    v_cvt_pk_bf16_f32 v203, v206, v207
    v_cvt_pk_bf16_f32 v208, v208, v209
    v_cvt_pk_bf16_f32 v209, v210, v211
    v_cvt_pk_bf16_f32 v210, v212, v213
    v_cvt_pk_bf16_f32 v211, v214, v215
    v_cvt_pk_bf16_f32 v216, v216, v217
    v_cvt_pk_bf16_f32 v217, v218, v219
    v_cvt_pk_bf16_f32 v218, v220, v221
    v_cvt_pk_bf16_f32 v219, v222, v223
    s_cmp_ge_u32 s58, 8
    s_cbranch_scc1 L_EV
    buffer_store_dwordx4 v[192:195], v9, s[24:27], s80 offen offset:0 sc1
    buffer_store_dwordx4 v[200:203], v9, s[24:27], s80 offen offset:256 sc1
    buffer_store_dwordx4 v[208:211], v9, s[24:27], s81 offen offset:0 sc1
    buffer_store_dwordx4 v[216:219], v9, s[24:27], s81 offen offset:256 sc1
    s_branch L_EF
L_EV:
    ds_write_b64 v10, v[192:193] offset:0
    ds_write_b64 v10, v[194:195] offset:16
    ds_write_b64 v10, v[200:201] offset:512
    ds_write_b64 v10, v[202:203] offset:528
    ds_write_b64 v10, v[208:209] offset:2048
    ds_write_b64 v10, v[210:211] offset:2064
    ds_write_b64 v10, v[216:217] offset:2560
    ds_write_b64 v10, v[218:219] offset:2576
    s_waitcnt lgkmcnt(0)
    ds_read_b64_tr_b16 v[224:225], v11 offset:0
    ds_read_b64_tr_b16 v[226:227], v11 offset:256
    ds_read_b64_tr_b16 v[228:229], v11 offset:512
    ds_read_b64_tr_b16 v[230:231], v11 offset:768
    ds_read_b64_tr_b16 v[232:233], v11 offset:2048
    ds_read_b64_tr_b16 v[234:235], v11 offset:2304
    ds_read_b64_tr_b16 v[236:237], v11 offset:2560
    ds_read_b64_tr_b16 v[238:239], v11 offset:2816
    s_waitcnt lgkmcnt(4)
    buffer_store_dwordx4 v[224:227], v12, s[24:27], s80 offen sc1
    buffer_store_dwordx4 v[228:231], v12, s[24:27], s80 offen offset:512 sc1
    s_waitcnt lgkmcnt(0)
    buffer_store_dwordx4 v[232:235], v12, s[24:27], s81 offen sc1
    buffer_store_dwordx4 v[236:239], v12, s[24:27], s81 offen offset:512 sc1
    s_cmp_lt_u32 s58, 12
    s_cbranch_scc1 L_EF
    v_and_b32 v16, 0x3ff, v8
    v_lshrrev_b32 v15, 5, v17
    v_lshl_add_u32 v16, v15, 16, v16
    v_mul_f32 v40, 0x3eb8aa3b, v22
    v_mul_f32 v42, 0x3eb8aa3b, v26
    v_mul_f32 v44, 0x3eb8aa3b, v30
    v_mul_f32 v46, 0x3eb8aa3b, v34
    v_pk_mul_f32 v[128:129], v[128:129], v[40:41] op_sel_hi:[1,0]
    v_pk_mul_f32 v[130:131], v[130:131], v[40:41] op_sel_hi:[1,0]
    v_pk_mul_f32 v[132:133], v[132:133], v[40:41] op_sel_hi:[1,0]
    v_pk_mul_f32 v[134:135], v[134:135], v[40:41] op_sel_hi:[1,0]
    v_cvt_pk_bf16_f32 v128, v128, v129
    v_cvt_pk_bf16_f32 v129, v130, v131
    v_cvt_pk_bf16_f32 v130, v132, v133
    v_cvt_pk_bf16_f32 v131, v134, v135
    s_add_u32 s63, s84, 0
    buffer_store_dwordx4 v[128:131], v16, s[24:27], s63 offen offset:0 sc1
    v_pk_mul_f32 v[136:137], v[136:137], v[40:41] op_sel_hi:[1,0]
    v_pk_mul_f32 v[138:139], v[138:139], v[40:41] op_sel_hi:[1,0]
    v_pk_mul_f32 v[140:141], v[140:141], v[40:41] op_sel_hi:[1,0]
    v_pk_mul_f32 v[142:143], v[142:143], v[40:41] op_sel_hi:[1,0]
    v_cvt_pk_bf16_f32 v136, v136, v137
    v_cvt_pk_bf16_f32 v137, v138, v139
    v_cvt_pk_bf16_f32 v138, v140, v141
    v_cvt_pk_bf16_f32 v139, v142, v143
    s_add_u32 s63, s84, 262144
    buffer_store_dwordx4 v[136:139], v16, s[24:27], s63 offen offset:0 sc1
    v_pk_mul_f32 v[144:145], v[144:145], v[42:43] op_sel_hi:[1,0]
    v_pk_mul_f32 v[146:147], v[146:147], v[42:43] op_sel_hi:[1,0]
    v_pk_mul_f32 v[148:149], v[148:149], v[42:43] op_sel_hi:[1,0]
    v_pk_mul_f32 v[150:151], v[150:151], v[42:43] op_sel_hi:[1,0]
    v_cvt_pk_bf16_f32 v144, v144, v145
    v_cvt_pk_bf16_f32 v145, v146, v147
    v_cvt_pk_bf16_f32 v146, v148, v149
    v_cvt_pk_bf16_f32 v147, v150, v151
    s_add_u32 s63, s84, 0
    buffer_store_dwordx4 v[144:147], v16, s[24:27], s63 offen offset:256 sc1
    v_pk_mul_f32 v[152:153], v[152:153], v[42:43] op_sel_hi:[1,0]
    v_pk_mul_f32 v[154:155], v[154:155], v[42:43] op_sel_hi:[1,0]
    v_pk_mul_f32 v[156:157], v[156:157], v[42:43] op_sel_hi:[1,0]
    v_pk_mul_f32 v[158:159], v[158:159], v[42:43] op_sel_hi:[1,0]
    v_cvt_pk_bf16_f32 v152, v152, v153
    v_cvt_pk_bf16_f32 v153, v154, v155
    v_cvt_pk_bf16_f32 v154, v156, v157
    v_cvt_pk_bf16_f32 v155, v158, v159
    s_add_u32 s63, s84, 262144
    buffer_store_dwordx4 v[152:155], v16, s[24:27], s63 offen offset:256 sc1
    v_pk_mul_f32 v[160:161], v[160:161], v[44:45] op_sel_hi:[1,0]
    v_pk_mul_f32 v[162:163], v[162:163], v[44:45] op_sel_hi:[1,0]
    v_pk_mul_f32 v[164:165], v[164:165], v[44:45] op_sel_hi:[1,0]
    v_pk_mul_f32 v[166:167], v[166:167], v[44:45] op_sel_hi:[1,0]
    v_cvt_pk_bf16_f32 v160, v160, v161
    v_cvt_pk_bf16_f32 v161, v162, v163
    v_cvt_pk_bf16_f32 v162, v164, v165
    v_cvt_pk_bf16_f32 v163, v166, v167
    s_add_u32 s63, s85, 0
    buffer_store_dwordx4 v[160:163], v16, s[24:27], s63 offen offset:0 sc1
    v_pk_mul_f32 v[168:169], v[168:169], v[44:45] op_sel_hi:[1,0]
    v_pk_mul_f32 v[170:171], v[170:171], v[44:45] op_sel_hi:[1,0]
    v_pk_mul_f32 v[172:173], v[172:173], v[44:45] op_sel_hi:[1,0]
    v_pk_mul_f32 v[174:175], v[174:175], v[44:45] op_sel_hi:[1,0]
    v_cvt_pk_bf16_f32 v168, v168, v169
    v_cvt_pk_bf16_f32 v169, v170, v171
    v_cvt_pk_bf16_f32 v170, v172, v173
    v_cvt_pk_bf16_f32 v171, v174, v175
    s_add_u32 s63, s85, 262144
    buffer_store_dwordx4 v[168:171], v16, s[24:27], s63 offen offset:0 sc1
    v_pk_mul_f32 v[176:177], v[176:177], v[46:47] op_sel_hi:[1,0]
    v_pk_mul_f32 v[178:179], v[178:179], v[46:47] op_sel_hi:[1,0]
    v_pk_mul_f32 v[180:181], v[180:181], v[46:47] op_sel_hi:[1,0]
    v_pk_mul_f32 v[182:183], v[182:183], v[46:47] op_sel_hi:[1,0]
    v_cvt_pk_bf16_f32 v176, v176, v177
    v_cvt_pk_bf16_f32 v177, v178, v179
    v_cvt_pk_bf16_f32 v178, v180, v181
    v_cvt_pk_bf16_f32 v179, v182, v183
    s_add_u32 s63, s85, 0
    buffer_store_dwordx4 v[176:179], v16, s[24:27], s63 offen offset:256 sc1
    v_pk_mul_f32 v[184:185], v[184:185], v[46:47] op_sel_hi:[1,0]
    v_pk_mul_f32 v[186:187], v[186:187], v[46:47] op_sel_hi:[1,0]
    v_pk_mul_f32 v[188:189], v[188:189], v[46:47] op_sel_hi:[1,0]
    v_pk_mul_f32 v[190:191], v[190:191], v[46:47] op_sel_hi:[1,0]
    v_cvt_pk_bf16_f32 v184, v184, v185
    v_cvt_pk_bf16_f32 v185, v186, v187
    v_cvt_pk_bf16_f32 v186, v188, v189
    v_cvt_pk_bf16_f32 v187, v190, v191
    s_add_u32 s63, s85, 262144
    buffer_store_dwordx4 v[184:187], v16, s[24:27], s63 offen offset:256 sc1
    s_branch L_EDONE
L_EF:
    v_pk_mul_f32 v[40:41], v[128:129], v[120:121] op_sel_hi:[1,0]
    v_pk_mul_f32 v[42:43], v[130:131], v[120:121] op_sel_hi:[1,0]
    v_pk_mul_f32 v[44:45], v[132:133], v[120:121] op_sel_hi:[1,0]
    v_pk_mul_f32 v[46:47], v[134:135], v[120:121] op_sel_hi:[1,0]
    v_exp_f32 v40, v40
    v_exp_f32 v41, v41
    v_exp_f32 v42, v42
    v_exp_f32 v43, v43
    v_exp_f32 v44, v44
    v_exp_f32 v45, v45
    v_exp_f32 v46, v46
    v_exp_f32 v47, v47
    v_pk_mul_f32 v[128:129], v[128:129], v[136:137]
    v_pk_mul_f32 v[130:131], v[130:131], v[138:139]
    v_pk_mul_f32 v[132:133], v[132:133], v[140:141]
    v_pk_mul_f32 v[134:135], v[134:135], v[142:143]
    v_pk_fma_f32 v[40:41], v[40:41], v[22:23], v[22:23] op_sel:[0,1,1] op_sel_hi:[1,1,1]
    v_pk_fma_f32 v[42:43], v[42:43], v[22:23], v[22:23] op_sel:[0,1,1] op_sel_hi:[1,1,1]
    v_pk_fma_f32 v[44:45], v[44:45], v[22:23], v[22:23] op_sel:[0,1,1] op_sel_hi:[1,1,1]
    v_pk_fma_f32 v[46:47], v[46:47], v[22:23], v[22:23] op_sel:[0,1,1] op_sel_hi:[1,1,1]
    v_rcp_f32 v40, v40
    v_rcp_f32 v41, v41
    v_rcp_f32 v42, v42
    v_rcp_f32 v43, v43
    v_rcp_f32 v44, v44
    v_rcp_f32 v45, v45
    v_rcp_f32 v46, v46
    v_rcp_f32 v47, v47
    s_nop 0
    v_pk_mul_f32 v[128:129], v[128:129], v[40:41]
    v_pk_mul_f32 v[130:131], v[130:131], v[42:43]
    v_pk_mul_f32 v[132:133], v[132:133], v[44:45]
    v_pk_mul_f32 v[134:135], v[134:135], v[46:47]
    v_cvt_pk_bf16_f32 v136, v128, v129
    v_cvt_pk_bf16_f32 v137, v130, v131
    v_cvt_pk_bf16_f32 v138, v132, v133
    v_cvt_pk_bf16_f32 v139, v134, v135
    v_pk_mul_f32 v[48:49], v[144:145], v[122:123] op_sel_hi:[1,0]
    v_pk_mul_f32 v[50:51], v[146:147], v[122:123] op_sel_hi:[1,0]
    v_pk_mul_f32 v[52:53], v[148:149], v[122:123] op_sel_hi:[1,0]
    v_pk_mul_f32 v[54:55], v[150:151], v[122:123] op_sel_hi:[1,0]
    v_exp_f32 v48, v48
    v_exp_f32 v49, v49
    v_exp_f32 v50, v50
    v_exp_f32 v51, v51
    v_exp_f32 v52, v52
    v_exp_f32 v53, v53
    v_exp_f32 v54, v54
    v_exp_f32 v55, v55
    v_pk_mul_f32 v[144:145], v[144:145], v[152:153]
    v_pk_mul_f32 v[146:147], v[146:147], v[154:155]
    v_pk_mul_f32 v[148:149], v[148:149], v[156:157]
    v_pk_mul_f32 v[150:151], v[150:151], v[158:159]
    v_pk_fma_f32 v[48:49], v[48:49], v[26:27], v[26:27] op_sel:[0,1,1] op_sel_hi:[1,1,1]
    v_pk_fma_f32 v[50:51], v[50:51], v[26:27], v[26:27] op_sel:[0,1,1] op_sel_hi:[1,1,1]
    v_pk_fma_f32 v[52:53], v[52:53], v[26:27], v[26:27] op_sel:[0,1,1] op_sel_hi:[1,1,1]
    v_pk_fma_f32 v[54:55], v[54:55], v[26:27], v[26:27] op_sel:[0,1,1] op_sel_hi:[1,1,1]
    v_rcp_f32 v48, v48
    v_rcp_f32 v49, v49
    v_rcp_f32 v50, v50
    v_rcp_f32 v51, v51
    v_rcp_f32 v52, v52
    v_rcp_f32 v53, v53
    v_rcp_f32 v54, v54
    v_rcp_f32 v55, v55
    s_nop 0
    v_pk_mul_f32 v[144:145], v[144:145], v[48:49]
    v_pk_mul_f32 v[146:147], v[146:147], v[50:51]
    v_pk_mul_f32 v[148:149], v[148:149], v[52:53]
    v_pk_mul_f32 v[150:151], v[150:151], v[54:55]
    v_cvt_pk_bf16_f32 v152, v144, v145
    v_cvt_pk_bf16_f32 v153, v146, v147
    v_cvt_pk_bf16_f32 v154, v148, v149
    v_cvt_pk_bf16_f32 v155, v150, v151
    v_pk_mul_f32 v[40:41], v[160:161], v[124:125] op_sel_hi:[1,0]
    v_pk_mul_f32 v[42:43], v[162:163], v[124:125] op_sel_hi:[1,0]
    v_pk_mul_f32 v[44:45], v[164:165], v[124:125] op_sel_hi:[1,0]
    v_pk_mul_f32 v[46:47], v[166:167], v[124:125] op_sel_hi:[1,0]
    v_exp_f32 v40, v40
    v_exp_f32 v41, v41
    v_exp_f32 v42, v42
    v_exp_f32 v43, v43
    v_exp_f32 v44, v44
    v_exp_f32 v45, v45
    v_exp_f32 v46, v46
    v_exp_f32 v47, v47
    v_pk_mul_f32 v[160:161], v[160:161], v[168:169]
    v_pk_mul_f32 v[162:163], v[162:163], v[170:171]
    v_pk_mul_f32 v[164:165], v[164:165], v[172:173]
    v_pk_mul_f32 v[166:167], v[166:167], v[174:175]
    v_pk_fma_f32 v[40:41], v[40:41], v[30:31], v[30:31] op_sel:[0,1,1] op_sel_hi:[1,1,1]
    v_pk_fma_f32 v[42:43], v[42:43], v[30:31], v[30:31] op_sel:[0,1,1] op_sel_hi:[1,1,1]
    v_pk_fma_f32 v[44:45], v[44:45], v[30:31], v[30:31] op_sel:[0,1,1] op_sel_hi:[1,1,1]
    v_pk_fma_f32 v[46:47], v[46:47], v[30:31], v[30:31] op_sel:[0,1,1] op_sel_hi:[1,1,1]
    v_rcp_f32 v40, v40
    v_rcp_f32 v41, v41
    v_rcp_f32 v42, v42
    v_rcp_f32 v43, v43
    v_rcp_f32 v44, v44
    v_rcp_f32 v45, v45
    v_rcp_f32 v46, v46
    v_rcp_f32 v47, v47
    s_nop 0
    v_pk_mul_f32 v[160:161], v[160:161], v[40:41]
    v_pk_mul_f32 v[162:163], v[162:163], v[42:43]
    v_pk_mul_f32 v[164:165], v[164:165], v[44:45]
    v_pk_mul_f32 v[166:167], v[166:167], v[46:47]
    v_cvt_pk_bf16_f32 v168, v160, v161
    v_cvt_pk_bf16_f32 v169, v162, v163
    v_cvt_pk_bf16_f32 v170, v164, v165
    v_cvt_pk_bf16_f32 v171, v166, v167
    v_pk_mul_f32 v[48:49], v[176:177], v[126:127] op_sel_hi:[1,0]
    v_pk_mul_f32 v[50:51], v[178:179], v[126:127] op_sel_hi:[1,0]
    v_pk_mul_f32 v[52:53], v[180:181], v[126:127] op_sel_hi:[1,0]
    v_pk_mul_f32 v[54:55], v[182:183], v[126:127] op_sel_hi:[1,0]
    v_exp_f32 v48, v48
    v_exp_f32 v49, v49
    v_exp_f32 v50, v50
    v_exp_f32 v51, v51
    v_exp_f32 v52, v52
    v_exp_f32 v53, v53
    v_exp_f32 v54, v54
    v_exp_f32 v55, v55
    v_pk_mul_f32 v[176:177], v[176:177], v[184:185]
    v_pk_mul_f32 v[178:179], v[178:179], v[186:187]
    v_pk_mul_f32 v[180:181], v[180:181], v[188:189]
    v_pk_mul_f32 v[182:183], v[182:183], v[190:191]
    v_pk_fma_f32 v[48:49], v[48:49], v[34:35], v[34:35] op_sel:[0,1,1] op_sel_hi:[1,1,1]
    v_pk_fma_f32 v[50:51], v[50:51], v[34:35], v[34:35] op_sel:[0,1,1] op_sel_hi:[1,1,1]
    v_pk_fma_f32 v[52:53], v[52:53], v[34:35], v[34:35] op_sel:[0,1,1] op_sel_hi:[1,1,1]
    v_pk_fma_f32 v[54:55], v[54:55], v[34:35], v[34:35] op_sel:[0,1,1] op_sel_hi:[1,1,1]
    v_rcp_f32 v48, v48
    v_rcp_f32 v49, v49
    v_rcp_f32 v50, v50
    v_rcp_f32 v51, v51
    v_rcp_f32 v52, v52
    v_rcp_f32 v53, v53
    v_rcp_f32 v54, v54
    v_rcp_f32 v55, v55
    s_nop 0
    v_pk_mul_f32 v[176:177], v[176:177], v[48:49]
    v_pk_mul_f32 v[178:179], v[178:179], v[50:51]
    v_pk_mul_f32 v[180:181], v[180:181], v[52:53]
    v_pk_mul_f32 v[182:183], v[182:183], v[54:55]
    v_cvt_pk_bf16_f32 v184, v176, v177
    v_cvt_pk_bf16_f32 v185, v178, v179
    v_cvt_pk_bf16_f32 v186, v180, v181
    v_cvt_pk_bf16_f32 v187, v182, v183
L_EDONE:
    s_barrier
    v_subrev_u32 v2, 81920, v2
    v_subrev_u32 v3, 81920, v3
    ds_read_b128 v[40:43], v2 offset:0
    ds_read_b64_tr_b16 v[72:73], v6 offset:0
    ds_read_b64_tr_b16 v[74:75], v6 offset:512
    ds_read_b128 v[44:47], v2 offset:2048
    ds_read_b128 v[48:51], v2 offset:4096
    ds_read_b128 v[52:55], v2 offset:6144
    ds_read_b64_tr_b16 v[76:77], v7 offset:0
    ds_read_b64_tr_b16 v[78:79], v7 offset:512
    ds_read_b64_tr_b16 v[80:81], v6 offset:2048
    ds_read_b64_tr_b16 v[82:83], v6 offset:2560
    ds_read_b64_tr_b16 v[84:85], v7 offset:2048
    ds_read_b64_tr_b16 v[86:87], v7 offset:2560
    s_waitcnt lgkmcnt(4)
    v_mfma_f32_16x16x32_bf16 v[192:195], v[72:75], v[40:43], 0
    ds_read_b128 v[56:59], v3 offset:0
    v_mfma_f32_16x16x32_bf16 v[208:211], v[72:75], v[44:47], 0
    ds_read_b64_tr_b16 v[96:97], v6 offset:8192
    v_mfma_f32_16x16x32_bf16 v[224:227], v[72:75], v[48:51], 0
    ds_read_b64_tr_b16 v[98:99], v6 offset:8704
    v_mfma_f32_16x16x32_bf16 v[240:243], v[72:75], v[52:55], 0
    ds_read_b128 v[60:63], v3 offset:2048
    v_mfma_f32_16x16x32_bf16 v[196:199], v[76:79], v[40:43], 0
    ds_read_b128 v[64:67], v3 offset:4096
    v_mfma_f32_16x16x32_bf16 v[212:215], v[76:79], v[44:47], 0
    ds_read_b128 v[68:71], v3 offset:6144
    v_mfma_f32_16x16x32_bf16 v[228:231], v[76:79], v[48:51], 0
    ds_read_b64_tr_b16 v[100:101], v7 offset:8192
    v_mfma_f32_16x16x32_bf16 v[244:247], v[76:79], v[52:55], 0
    ds_read_b64_tr_b16 v[102:103], v7 offset:8704
    s_waitcnt lgkmcnt(8)
    v_mfma_f32_16x16x32_bf16 v[200:203], v[80:83], v[40:43], 0
    ds_read_b64_tr_b16 v[104:105], v6 offset:10240
    v_mfma_f32_16x16x32_bf16 v[216:219], v[80:83], v[44:47], 0
    ds_read_b64_tr_b16 v[106:107], v6 offset:10752
    v_mfma_f32_16x16x32_bf16 v[232:235], v[80:83], v[48:51], 0
    ds_read_b64_tr_b16 v[108:109], v7 offset:10240
    v_mfma_f32_16x16x32_bf16 v[248:251], v[80:83], v[52:55], 0
    ds_read_b64_tr_b16 v[110:111], v7 offset:10752
    v_mfma_f32_16x16x32_bf16 v[204:207], v[84:87], v[40:43], 0
    v_mfma_f32_16x16x32_bf16 v[220:223], v[84:87], v[44:47], 0
    v_mfma_f32_16x16x32_bf16 v[236:239], v[84:87], v[48:51], 0
    v_mfma_f32_16x16x32_bf16 v[252:255], v[84:87], v[52:55], 0
    s_waitcnt lgkmcnt(4)
    v_mfma_f32_16x16x32_bf16 v[192:195], v[96:99], v[56:59], v[192:195]
    v_mfma_f32_16x16x32_bf16 v[208:211], v[96:99], v[60:63], v[208:211]
    v_mfma_f32_16x16x32_bf16 v[224:227], v[96:99], v[64:67], v[224:227]
    v_mfma_f32_16x16x32_bf16 v[240:243], v[96:99], v[68:71], v[240:243]
    s_waitcnt vmcnt(0)
    s_waitcnt lgkmcnt(0)
    s_barrier
    v_mfma_f32_16x16x32_bf16 v[196:199], v[100:103], v[56:59], v[196:199]
    ds_read_b128 v[40:43], v2 offset:40960
    v_mfma_f32_16x16x32_bf16 v[212:215], v[100:103], v[60:63], v[212:215]
    ds_read_b64_tr_b16 v[72:73], v6 offset:40960
    v_mfma_f32_16x16x32_bf16 v[228:231], v[100:103], v[64:67], v[228:231]
    ds_read_b64_tr_b16 v[74:75], v6 offset:41472
    v_mfma_f32_16x16x32_bf16 v[244:247], v[100:103], v[68:71], v[244:247]
    ds_read_b128 v[44:47], v2 offset:43008
    v_mfma_f32_16x16x32_bf16 v[200:203], v[104:107], v[56:59], v[200:203]
    ds_read_b128 v[48:51], v2 offset:45056
    v_mfma_f32_16x16x32_bf16 v[216:219], v[104:107], v[60:63], v[216:219]
    ds_read_b128 v[52:55], v2 offset:47104
    v_mfma_f32_16x16x32_bf16 v[232:235], v[104:107], v[64:67], v[232:235]
    ds_read_b64_tr_b16 v[76:77], v7 offset:40960
    v_mfma_f32_16x16x32_bf16 v[248:251], v[104:107], v[68:71], v[248:251]
    ds_read_b64_tr_b16 v[78:79], v7 offset:41472
    v_mfma_f32_16x16x32_bf16 v[204:207], v[108:111], v[56:59], v[204:207]
    ds_read_b64_tr_b16 v[80:81], v6 offset:43008
    v_mfma_f32_16x16x32_bf16 v[220:223], v[108:111], v[60:63], v[220:223]
    ds_read_b64_tr_b16 v[82:83], v6 offset:43520
    v_mfma_f32_16x16x32_bf16 v[236:239], v[108:111], v[64:67], v[236:239]
    ds_read_b64_tr_b16 v[84:85], v7 offset:43008
    v_mfma_f32_16x16x32_bf16 v[252:255], v[108:111], v[68:71], v[252:255]
    ds_read_b64_tr_b16 v[86:87], v7 offset:43520
    v_mov_b32 v15, 19038208
    s_mov_b64 exec, 1
    buffer_store_dwordx4 v[36:39], v15, s[24:27], s72 offen sc1
    s_mov_b64 exec, -1
    s_waitcnt lgkmcnt(4)
    v_mfma_f32_16x16x32_bf16 v[192:195], v[72:75], v[40:43], v[192:195]
    ds_read_b128 v[56:59], v3 offset:40960
    v_mfma_f32_16x16x32_bf16 v[208:211], v[72:75], v[44:47], v[208:211]
    ds_read_b64_tr_b16 v[96:97], v6 offset:49152
    v_mfma_f32_16x16x32_bf16 v[224:227], v[72:75], v[48:51], v[224:227]
    ds_read_b64_tr_b16 v[98:99], v6 offset:49664
    v_mfma_f32_16x16x32_bf16 v[240:243], v[72:75], v[52:55], v[240:243]
    ds_read_b128 v[60:63], v3 offset:43008
    v_mfma_f32_16x16x32_bf16 v[196:199], v[76:79], v[40:43], v[196:199]
    ds_read_b128 v[64:67], v3 offset:45056
    v_mfma_f32_16x16x32_bf16 v[212:215], v[76:79], v[44:47], v[212:215]
    ds_read_b128 v[68:71], v3 offset:47104
    v_mfma_f32_16x16x32_bf16 v[228:231], v[76:79], v[48:51], v[228:231]
    ds_read_b64_tr_b16 v[100:101], v7 offset:49152
    v_mfma_f32_16x16x32_bf16 v[244:247], v[76:79], v[52:55], v[244:247]
    ds_read_b64_tr_b16 v[102:103], v7 offset:49664
    s_waitcnt lgkmcnt(8)
    v_mfma_f32_16x16x32_bf16 v[200:203], v[80:83], v[40:43], v[200:203]
    ds_read_b64_tr_b16 v[104:105], v6 offset:51200
    v_mfma_f32_16x16x32_bf16 v[216:219], v[80:83], v[44:47], v[216:219]
    ds_read_b64_tr_b16 v[106:107], v6 offset:51712
    v_mfma_f32_16x16x32_bf16 v[232:235], v[80:83], v[48:51], v[232:235]
    ds_read_b64_tr_b16 v[108:109], v7 offset:51200
    v_mfma_f32_16x16x32_bf16 v[248:251], v[80:83], v[52:55], v[248:251]
    ds_read_b64_tr_b16 v[110:111], v7 offset:51712
    v_mfma_f32_16x16x32_bf16 v[204:207], v[84:87], v[40:43], v[204:207]
    v_mfma_f32_16x16x32_bf16 v[220:223], v[84:87], v[44:47], v[220:223]
    v_mfma_f32_16x16x32_bf16 v[236:239], v[84:87], v[48:51], v[236:239]
    v_mfma_f32_16x16x32_bf16 v[252:255], v[84:87], v[52:55], v[252:255]
    s_waitcnt lgkmcnt(4)
    v_mfma_f32_16x16x32_bf16 v[192:195], v[96:99], v[56:59], v[192:195]
    v_mfma_f32_16x16x32_bf16 v[208:211], v[96:99], v[60:63], v[208:211]
    v_mfma_f32_16x16x32_bf16 v[224:227], v[96:99], v[64:67], v[224:227]
    v_mfma_f32_16x16x32_bf16 v[240:243], v[96:99], v[68:71], v[240:243]
    s_waitcnt lgkmcnt(0)
    s_barrier
    v_mfma_f32_16x16x32_bf16 v[196:199], v[100:103], v[56:59], v[196:199]
    v_add_u32 v6, 81920, v6
    v_add_u32 v7, 81920, v7
    v_mfma_f32_16x16x32_bf16 v[212:215], v[100:103], v[60:63], v[212:215]
    v_add_u32 v2, 81920, v2
    v_add_u32 v3, 81920, v3
    v_mfma_f32_16x16x32_bf16 v[228:231], v[100:103], v[64:67], v[228:231]
    ds_read_b128 v[40:43], v2 offset:0
    v_mfma_f32_16x16x32_bf16 v[244:247], v[100:103], v[68:71], v[244:247]
    ds_read_b64_tr_b16 v[72:73], v6 offset:0
    v_mfma_f32_16x16x32_bf16 v[200:203], v[104:107], v[56:59], v[200:203]
    ds_read_b64_tr_b16 v[74:75], v6 offset:512
    v_mfma_f32_16x16x32_bf16 v[216:219], v[104:107], v[60:63], v[216:219]
    ds_read_b128 v[44:47], v2 offset:2048
    v_mfma_f32_16x16x32_bf16 v[232:235], v[104:107], v[64:67], v[232:235]
    ds_read_b128 v[48:51], v2 offset:4096
    v_mfma_f32_16x16x32_bf16 v[248:251], v[104:107], v[68:71], v[248:251]
    ds_read_b128 v[52:55], v2 offset:6144
    v_mfma_f32_16x16x32_bf16 v[204:207], v[108:111], v[56:59], v[204:207]
    ds_read_b64_tr_b16 v[76:77], v7 offset:0
    v_mfma_f32_16x16x32_bf16 v[220:223], v[108:111], v[60:63], v[220:223]
    ds_read_b64_tr_b16 v[78:79], v7 offset:512
    v_mfma_f32_16x16x32_bf16 v[236:239], v[108:111], v[64:67], v[236:239]
    ds_read_b64_tr_b16 v[80:81], v6 offset:2048
    v_mfma_f32_16x16x32_bf16 v[252:255], v[108:111], v[68:71], v[252:255]
    ds_read_b64_tr_b16 v[82:83], v6 offset:2560
    ds_read_b64_tr_b16 v[84:85], v7 offset:2048
    ds_read_b64_tr_b16 v[86:87], v7 offset:2560
    s_waitcnt lgkmcnt(4)
    v_mfma_f32_16x16x32_bf16 v[192:195], v[72:75], v[40:43], v[192:195]
    ds_read_b128 v[56:59], v3 offset:0
    v_mfma_f32_16x16x32_bf16 v[208:211], v[72:75], v[44:47], v[208:211]
    ds_read_b64_tr_b16 v[96:97], v6 offset:8192
    v_mfma_f32_16x16x32_bf16 v[224:227], v[72:75], v[48:51], v[224:227]
    ds_read_b64_tr_b16 v[98:99], v6 offset:8704
    v_mfma_f32_16x16x32_bf16 v[240:243], v[72:75], v[52:55], v[240:243]
    ds_read_b128 v[60:63], v3 offset:2048
    v_mfma_f32_16x16x32_bf16 v[196:199], v[76:79], v[40:43], v[196:199]
    ds_read_b128 v[64:67], v3 offset:4096
    v_mfma_f32_16x16x32_bf16 v[212:215], v[76:79], v[44:47], v[212:215]
    ds_read_b128 v[68:71], v3 offset:6144
    v_mfma_f32_16x16x32_bf16 v[228:231], v[76:79], v[48:51], v[228:231]
    ds_read_b64_tr_b16 v[100:101], v7 offset:8192
    v_mfma_f32_16x16x32_bf16 v[244:247], v[76:79], v[52:55], v[244:247]
    ds_read_b64_tr_b16 v[102:103], v7 offset:8704
    s_waitcnt lgkmcnt(8)
    v_mfma_f32_16x16x32_bf16 v[200:203], v[80:83], v[40:43], v[200:203]
    ds_read_b64_tr_b16 v[104:105], v6 offset:10240
    v_mfma_f32_16x16x32_bf16 v[216:219], v[80:83], v[44:47], v[216:219]
    ds_read_b64_tr_b16 v[106:107], v6 offset:10752
    v_mfma_f32_16x16x32_bf16 v[232:235], v[80:83], v[48:51], v[232:235]
    ds_read_b64_tr_b16 v[108:109], v7 offset:10240
    v_mfma_f32_16x16x32_bf16 v[248:251], v[80:83], v[52:55], v[248:251]
    ds_read_b64_tr_b16 v[110:111], v7 offset:10752
    v_mfma_f32_16x16x32_bf16 v[204:207], v[84:87], v[40:43], v[204:207]
    v_mfma_f32_16x16x32_bf16 v[220:223], v[84:87], v[44:47], v[220:223]
    v_mfma_f32_16x16x32_bf16 v[236:239], v[84:87], v[48:51], v[236:239]
    v_mfma_f32_16x16x32_bf16 v[252:255], v[84:87], v[52:55], v[252:255]
    s_waitcnt lgkmcnt(4)
    v_mfma_f32_16x16x32_bf16 v[192:195], v[96:99], v[56:59], v[192:195]
    v_mfma_f32_16x16x32_bf16 v[208:211], v[96:99], v[60:63], v[208:211]
    v_mfma_f32_16x16x32_bf16 v[224:227], v[96:99], v[64:67], v[224:227]
    v_mfma_f32_16x16x32_bf16 v[240:243], v[96:99], v[68:71], v[240:243]
    s_waitcnt lgkmcnt(0)
    s_barrier
    v_mfma_f32_16x16x32_bf16 v[196:199], v[100:103], v[56:59], v[196:199]
    ds_read_b128 v[40:43], v2 offset:40960
    v_mfma_f32_16x16x32_bf16 v[212:215], v[100:103], v[60:63], v[212:215]
    ds_read_b64_tr_b16 v[72:73], v6 offset:40960
    v_mfma_f32_16x16x32_bf16 v[228:231], v[100:103], v[64:67], v[228:231]
    ds_read_b64_tr_b16 v[74:75], v6 offset:41472
    v_mfma_f32_16x16x32_bf16 v[244:247], v[100:103], v[68:71], v[244:247]
    ds_read_b128 v[44:47], v2 offset:43008
    v_mfma_f32_16x16x32_bf16 v[200:203], v[104:107], v[56:59], v[200:203]
    ds_read_b128 v[48:51], v2 offset:45056
    v_mfma_f32_16x16x32_bf16 v[216:219], v[104:107], v[60:63], v[216:219]
    ds_read_b128 v[52:55], v2 offset:47104
    v_mfma_f32_16x16x32_bf16 v[232:235], v[104:107], v[64:67], v[232:235]
    ds_read_b64_tr_b16 v[76:77], v7 offset:40960
    v_mfma_f32_16x16x32_bf16 v[248:251], v[104:107], v[68:71], v[248:251]
    ds_read_b64_tr_b16 v[78:79], v7 offset:41472
    v_mfma_f32_16x16x32_bf16 v[204:207], v[108:111], v[56:59], v[204:207]
    ds_read_b64_tr_b16 v[80:81], v6 offset:43008
    v_mfma_f32_16x16x32_bf16 v[220:223], v[108:111], v[60:63], v[220:223]
    ds_read_b64_tr_b16 v[82:83], v6 offset:43520
    v_mfma_f32_16x16x32_bf16 v[236:239], v[108:111], v[64:67], v[236:239]
    ds_read_b64_tr_b16 v[84:85], v7 offset:43008
    v_mfma_f32_16x16x32_bf16 v[252:255], v[108:111], v[68:71], v[252:255]
    ds_read_b64_tr_b16 v[86:87], v7 offset:43520
    s_waitcnt lgkmcnt(4)
    v_mfma_f32_16x16x32_bf16 v[192:195], v[72:75], v[40:43], v[192:195]
    ds_read_b128 v[56:59], v3 offset:40960
    v_mfma_f32_16x16x32_bf16 v[208:211], v[72:75], v[44:47], v[208:211]
    ds_read_b64_tr_b16 v[96:97], v6 offset:49152
    v_mfma_f32_16x16x32_bf16 v[224:227], v[72:75], v[48:51], v[224:227]
    ds_read_b64_tr_b16 v[98:99], v6 offset:49664
    v_mfma_f32_16x16x32_bf16 v[240:243], v[72:75], v[52:55], v[240:243]
    ds_read_b128 v[60:63], v3 offset:43008
    v_mfma_f32_16x16x32_bf16 v[196:199], v[76:79], v[40:43], v[196:199]
    ds_read_b128 v[64:67], v3 offset:45056
    v_mfma_f32_16x16x32_bf16 v[212:215], v[76:79], v[44:47], v[212:215]
    ds_read_b128 v[68:71], v3 offset:47104
    v_mfma_f32_16x16x32_bf16 v[228:231], v[76:79], v[48:51], v[228:231]
    ds_read_b64_tr_b16 v[100:101], v7 offset:49152
    v_mfma_f32_16x16x32_bf16 v[244:247], v[76:79], v[52:55], v[244:247]
    ds_read_b64_tr_b16 v[102:103], v7 offset:49664
    s_waitcnt lgkmcnt(8)
    v_mfma_f32_16x16x32_bf16 v[200:203], v[80:83], v[40:43], v[200:203]
    ds_read_b64_tr_b16 v[104:105], v6 offset:51200
    v_mfma_f32_16x16x32_bf16 v[216:219], v[80:83], v[44:47], v[216:219]
    ds_read_b64_tr_b16 v[106:107], v6 offset:51712
    v_mfma_f32_16x16x32_bf16 v[232:235], v[80:83], v[48:51], v[232:235]
    ds_read_b64_tr_b16 v[108:109], v7 offset:51200
    v_mfma_f32_16x16x32_bf16 v[248:251], v[80:83], v[52:55], v[248:251]
    ds_read_b64_tr_b16 v[110:111], v7 offset:51712
    v_mfma_f32_16x16x32_bf16 v[204:207], v[84:87], v[40:43], v[204:207]
    v_mfma_f32_16x16x32_bf16 v[220:223], v[84:87], v[44:47], v[220:223]
    v_mfma_f32_16x16x32_bf16 v[236:239], v[84:87], v[48:51], v[236:239]
    v_mfma_f32_16x16x32_bf16 v[252:255], v[84:87], v[52:55], v[252:255]
    s_waitcnt lgkmcnt(4)
    v_mfma_f32_16x16x32_bf16 v[192:195], v[96:99], v[56:59], v[192:195]
    v_mfma_f32_16x16x32_bf16 v[208:211], v[96:99], v[60:63], v[208:211]
    v_mfma_f32_16x16x32_bf16 v[224:227], v[96:99], v[64:67], v[224:227]
    v_mfma_f32_16x16x32_bf16 v[240:243], v[96:99], v[68:71], v[240:243]
    s_waitcnt lgkmcnt(0)
    s_barrier
    v_mfma_f32_16x16x32_bf16 v[196:199], v[100:103], v[56:59], v[196:199]
    v_subrev_u32 v6, 81920, v6
    v_subrev_u32 v7, 81920, v7
    v_mfma_f32_16x16x32_bf16 v[212:215], v[100:103], v[60:63], v[212:215]
    v_subrev_u32 v2, 81920, v2
    v_subrev_u32 v3, 81920, v3
    v_mfma_f32_16x16x32_bf16 v[228:231], v[100:103], v[64:67], v[228:231]
    ds_read_b128 v[40:43], v2 offset:0
    v_mfma_f32_16x16x32_bf16 v[244:247], v[100:103], v[68:71], v[244:247]
    ds_read_b64_tr_b16 v[72:73], v6 offset:0
    v_mfma_f32_16x16x32_bf16 v[200:203], v[104:107], v[56:59], v[200:203]
    ds_read_b64_tr_b16 v[74:75], v6 offset:512
    v_mfma_f32_16x16x32_bf16 v[216:219], v[104:107], v[60:63], v[216:219]
    ds_read_b128 v[44:47], v2 offset:2048
    v_mfma_f32_16x16x32_bf16 v[232:235], v[104:107], v[64:67], v[232:235]
    ds_read_b128 v[48:51], v2 offset:4096
    v_mfma_f32_16x16x32_bf16 v[248:251], v[104:107], v[68:71], v[248:251]
    ds_read_b128 v[52:55], v2 offset:6144
    v_mfma_f32_16x16x32_bf16 v[204:207], v[108:111], v[56:59], v[204:207]
    ds_read_b64_tr_b16 v[76:77], v7 offset:0
    v_mfma_f32_16x16x32_bf16 v[220:223], v[108:111], v[60:63], v[220:223]
    ds_read_b64_tr_b16 v[78:79], v7 offset:512
    v_mfma_f32_16x16x32_bf16 v[236:239], v[108:111], v[64:67], v[236:239]
    ds_read_b64_tr_b16 v[80:81], v6 offset:2048
    v_mfma_f32_16x16x32_bf16 v[252:255], v[108:111], v[68:71], v[252:255]
    ds_read_b64_tr_b16 v[82:83], v6 offset:2560
    ds_read_b64_tr_b16 v[84:85], v7 offset:2048
    ds_read_b64_tr_b16 v[86:87], v7 offset:2560
    s_waitcnt lgkmcnt(4)
    v_mfma_f32_16x16x32_bf16 v[192:195], v[72:75], v[40:43], v[192:195]
    ds_read_b128 v[56:59], v3 offset:0
    v_mfma_f32_16x16x32_bf16 v[208:211], v[72:75], v[44:47], v[208:211]
    ds_read_b64_tr_b16 v[96:97], v6 offset:8192
    v_mfma_f32_16x16x32_bf16 v[224:227], v[72:75], v[48:51], v[224:227]
    ds_read_b64_tr_b16 v[98:99], v6 offset:8704
    v_mfma_f32_16x16x32_bf16 v[240:243], v[72:75], v[52:55], v[240:243]
    ds_read_b128 v[60:63], v3 offset:2048
    v_mfma_f32_16x16x32_bf16 v[196:199], v[76:79], v[40:43], v[196:199]
    ds_read_b128 v[64:67], v3 offset:4096
    v_mfma_f32_16x16x32_bf16 v[212:215], v[76:79], v[44:47], v[212:215]
    ds_read_b128 v[68:71], v3 offset:6144
    v_mfma_f32_16x16x32_bf16 v[228:231], v[76:79], v[48:51], v[228:231]
    ds_read_b64_tr_b16 v[100:101], v7 offset:8192
    v_mfma_f32_16x16x32_bf16 v[244:247], v[76:79], v[52:55], v[244:247]
    ds_read_b64_tr_b16 v[102:103], v7 offset:8704
    s_waitcnt lgkmcnt(8)
    v_mfma_f32_16x16x32_bf16 v[200:203], v[80:83], v[40:43], v[200:203]
    ds_read_b64_tr_b16 v[104:105], v6 offset:10240
    v_mfma_f32_16x16x32_bf16 v[216:219], v[80:83], v[44:47], v[216:219]
    ds_read_b64_tr_b16 v[106:107], v6 offset:10752
    v_mfma_f32_16x16x32_bf16 v[232:235], v[80:83], v[48:51], v[232:235]
    ds_read_b64_tr_b16 v[108:109], v7 offset:10240
    v_mfma_f32_16x16x32_bf16 v[248:251], v[80:83], v[52:55], v[248:251]
    ds_read_b64_tr_b16 v[110:111], v7 offset:10752
    v_mfma_f32_16x16x32_bf16 v[204:207], v[84:87], v[40:43], v[204:207]
    v_mfma_f32_16x16x32_bf16 v[220:223], v[84:87], v[44:47], v[220:223]
    v_mfma_f32_16x16x32_bf16 v[236:239], v[84:87], v[48:51], v[236:239]
    v_mfma_f32_16x16x32_bf16 v[252:255], v[84:87], v[52:55], v[252:255]
    s_waitcnt lgkmcnt(4)
    v_mfma_f32_16x16x32_bf16 v[192:195], v[96:99], v[56:59], v[192:195]
    v_mfma_f32_16x16x32_bf16 v[208:211], v[96:99], v[60:63], v[208:211]
    v_mfma_f32_16x16x32_bf16 v[224:227], v[96:99], v[64:67], v[224:227]
    v_mfma_f32_16x16x32_bf16 v[240:243], v[96:99], v[68:71], v[240:243]
    s_waitcnt lgkmcnt(0)
    s_barrier
    v_mfma_f32_16x16x32_bf16 v[196:199], v[100:103], v[56:59], v[196:199]
    ds_read_b128 v[40:43], v2 offset:40960
    v_mfma_f32_16x16x32_bf16 v[212:215], v[100:103], v[60:63], v[212:215]
    ds_read_b64_tr_b16 v[72:73], v6 offset:40960
    v_mfma_f32_16x16x32_bf16 v[228:231], v[100:103], v[64:67], v[228:231]
    ds_read_b64_tr_b16 v[74:75], v6 offset:41472
    v_mfma_f32_16x16x32_bf16 v[244:247], v[100:103], v[68:71], v[244:247]
    ds_read_b128 v[44:47], v2 offset:43008
    v_mfma_f32_16x16x32_bf16 v[200:203], v[104:107], v[56:59], v[200:203]
    ds_read_b128 v[48:51], v2 offset:45056
    v_mfma_f32_16x16x32_bf16 v[216:219], v[104:107], v[60:63], v[216:219]
    ds_read_b128 v[52:55], v2 offset:47104
    v_mfma_f32_16x16x32_bf16 v[232:235], v[104:107], v[64:67], v[232:235]
    ds_read_b64_tr_b16 v[76:77], v7 offset:40960
    v_mfma_f32_16x16x32_bf16 v[248:251], v[104:107], v[68:71], v[248:251]
    ds_read_b64_tr_b16 v[78:79], v7 offset:41472
    v_mfma_f32_16x16x32_bf16 v[204:207], v[108:111], v[56:59], v[204:207]
    ds_read_b64_tr_b16 v[80:81], v6 offset:43008
    v_mfma_f32_16x16x32_bf16 v[220:223], v[108:111], v[60:63], v[220:223]
    ds_read_b64_tr_b16 v[82:83], v6 offset:43520
    v_mfma_f32_16x16x32_bf16 v[236:239], v[108:111], v[64:67], v[236:239]
    ds_read_b64_tr_b16 v[84:85], v7 offset:43008
    v_mfma_f32_16x16x32_bf16 v[252:255], v[108:111], v[68:71], v[252:255]
    ds_read_b64_tr_b16 v[86:87], v7 offset:43520
    s_waitcnt lgkmcnt(4)
    v_mfma_f32_16x16x32_bf16 v[192:195], v[72:75], v[40:43], v[192:195]
    ds_read_b128 v[56:59], v3 offset:40960
    v_mfma_f32_16x16x32_bf16 v[208:211], v[72:75], v[44:47], v[208:211]
    ds_read_b64_tr_b16 v[96:97], v6 offset:49152
    v_mfma_f32_16x16x32_bf16 v[224:227], v[72:75], v[48:51], v[224:227]
    ds_read_b64_tr_b16 v[98:99], v6 offset:49664
    v_mfma_f32_16x16x32_bf16 v[240:243], v[72:75], v[52:55], v[240:243]
    ds_read_b128 v[60:63], v3 offset:43008
    v_mfma_f32_16x16x32_bf16 v[196:199], v[76:79], v[40:43], v[196:199]
    ds_read_b128 v[64:67], v3 offset:45056
    v_mfma_f32_16x16x32_bf16 v[212:215], v[76:79], v[44:47], v[212:215]
    ds_read_b128 v[68:71], v3 offset:47104
    v_mfma_f32_16x16x32_bf16 v[228:231], v[76:79], v[48:51], v[228:231]
    ds_read_b64_tr_b16 v[100:101], v7 offset:49152
    v_mfma_f32_16x16x32_bf16 v[244:247], v[76:79], v[52:55], v[244:247]
    ds_read_b64_tr_b16 v[102:103], v7 offset:49664
    s_waitcnt lgkmcnt(8)
    v_mfma_f32_16x16x32_bf16 v[200:203], v[80:83], v[40:43], v[200:203]
    ds_read_b64_tr_b16 v[104:105], v6 offset:51200
    v_mfma_f32_16x16x32_bf16 v[216:219], v[80:83], v[44:47], v[216:219]
    ds_read_b64_tr_b16 v[106:107], v6 offset:51712
    v_mfma_f32_16x16x32_bf16 v[232:235], v[80:83], v[48:51], v[232:235]
    ds_read_b64_tr_b16 v[108:109], v7 offset:51200
    v_mfma_f32_16x16x32_bf16 v[248:251], v[80:83], v[52:55], v[248:251]
    ds_read_b64_tr_b16 v[110:111], v7 offset:51712
    v_mfma_f32_16x16x32_bf16 v[204:207], v[84:87], v[40:43], v[204:207]
    v_mfma_f32_16x16x32_bf16 v[220:223], v[84:87], v[44:47], v[220:223]
    v_mfma_f32_16x16x32_bf16 v[236:239], v[84:87], v[48:51], v[236:239]
    v_mfma_f32_16x16x32_bf16 v[252:255], v[84:87], v[52:55], v[252:255]
    s_waitcnt lgkmcnt(4)
    v_mfma_f32_16x16x32_bf16 v[192:195], v[96:99], v[56:59], v[192:195]
    v_mfma_f32_16x16x32_bf16 v[208:211], v[96:99], v[60:63], v[208:211]
    v_mfma_f32_16x16x32_bf16 v[224:227], v[96:99], v[64:67], v[224:227]
    v_mfma_f32_16x16x32_bf16 v[240:243], v[96:99], v[68:71], v[240:243]
    s_waitcnt lgkmcnt(0)
    s_barrier
    v_mfma_f32_16x16x32_bf16 v[196:199], v[100:103], v[56:59], v[196:199]
    v_add_u32 v6, 81920, v6
    v_add_u32 v7, 81920, v7
    v_mfma_f32_16x16x32_bf16 v[212:215], v[100:103], v[60:63], v[212:215]
    v_add_u32 v2, 81920, v2
    v_add_u32 v3, 81920, v3
    v_mfma_f32_16x16x32_bf16 v[228:231], v[100:103], v[64:67], v[228:231]
    ds_read_b128 v[40:43], v2 offset:0
    v_mfma_f32_16x16x32_bf16 v[244:247], v[100:103], v[68:71], v[244:247]
    ds_read_b64_tr_b16 v[72:73], v6 offset:0
    v_mfma_f32_16x16x32_bf16 v[200:203], v[104:107], v[56:59], v[200:203]
    ds_read_b64_tr_b16 v[74:75], v6 offset:512
    v_mfma_f32_16x16x32_bf16 v[216:219], v[104:107], v[60:63], v[216:219]
    ds_read_b128 v[44:47], v2 offset:2048
    v_mfma_f32_16x16x32_bf16 v[232:235], v[104:107], v[64:67], v[232:235]
    ds_read_b128 v[48:51], v2 offset:4096
    v_mfma_f32_16x16x32_bf16 v[248:251], v[104:107], v[68:71], v[248:251]
    ds_read_b128 v[52:55], v2 offset:6144
    v_mfma_f32_16x16x32_bf16 v[204:207], v[108:111], v[56:59], v[204:207]
    ds_read_b64_tr_b16 v[76:77], v7 offset:0
    v_mfma_f32_16x16x32_bf16 v[220:223], v[108:111], v[60:63], v[220:223]
    ds_read_b64_tr_b16 v[78:79], v7 offset:512
    v_mfma_f32_16x16x32_bf16 v[236:239], v[108:111], v[64:67], v[236:239]
    ds_read_b64_tr_b16 v[80:81], v6 offset:2048
    v_mfma_f32_16x16x32_bf16 v[252:255], v[108:111], v[68:71], v[252:255]
    ds_read_b64_tr_b16 v[82:83], v6 offset:2560
    ds_read_b64_tr_b16 v[84:85], v7 offset:2048
    ds_read_b64_tr_b16 v[86:87], v7 offset:2560
    s_waitcnt lgkmcnt(4)
    v_mfma_f32_16x16x32_bf16 v[192:195], v[72:75], v[40:43], v[192:195]
    ds_read_b128 v[56:59], v3 offset:0
    v_mfma_f32_16x16x32_bf16 v[208:211], v[72:75], v[44:47], v[208:211]
    ds_read_b64_tr_b16 v[96:97], v6 offset:8192
    v_mfma_f32_16x16x32_bf16 v[224:227], v[72:75], v[48:51], v[224:227]
    ds_read_b64_tr_b16 v[98:99], v6 offset:8704
    v_mfma_f32_16x16x32_bf16 v[240:243], v[72:75], v[52:55], v[240:243]
    ds_read_b128 v[60:63], v3 offset:2048
    v_mfma_f32_16x16x32_bf16 v[196:199], v[76:79], v[40:43], v[196:199]
    ds_read_b128 v[64:67], v3 offset:4096
    v_mfma_f32_16x16x32_bf16 v[212:215], v[76:79], v[44:47], v[212:215]
    ds_read_b128 v[68:71], v3 offset:6144
    v_mfma_f32_16x16x32_bf16 v[228:231], v[76:79], v[48:51], v[228:231]
    ds_read_b64_tr_b16 v[100:101], v7 offset:8192
    v_mfma_f32_16x16x32_bf16 v[244:247], v[76:79], v[52:55], v[244:247]
    ds_read_b64_tr_b16 v[102:103], v7 offset:8704
    s_waitcnt lgkmcnt(8)
    v_mfma_f32_16x16x32_bf16 v[200:203], v[80:83], v[40:43], v[200:203]
    ds_read_b64_tr_b16 v[104:105], v6 offset:10240
    v_mfma_f32_16x16x32_bf16 v[216:219], v[80:83], v[44:47], v[216:219]
    ds_read_b64_tr_b16 v[106:107], v6 offset:10752
    v_mfma_f32_16x16x32_bf16 v[232:235], v[80:83], v[48:51], v[232:235]
    ds_read_b64_tr_b16 v[108:109], v7 offset:10240
    v_mfma_f32_16x16x32_bf16 v[248:251], v[80:83], v[52:55], v[248:251]
    ds_read_b64_tr_b16 v[110:111], v7 offset:10752
    v_mfma_f32_16x16x32_bf16 v[204:207], v[84:87], v[40:43], v[204:207]
    v_add_u32 v16, 114688, v14
    v_mfma_f32_16x16x32_bf16 v[220:223], v[84:87], v[44:47], v[220:223]
    ds_read2_b32 v[128:129], v16 offset0:0 offset1:32
    v_mfma_f32_16x16x32_bf16 v[236:239], v[84:87], v[48:51], v[236:239]
    ds_read2_b32 v[130:131], v16 offset0:64 offset1:96
    v_mfma_f32_16x16x32_bf16 v[252:255], v[84:87], v[52:55], v[252:255]
    ds_read2_b32 v[132:133], v16 offset0:128 offset1:160
    s_waitcnt lgkmcnt(7)
    v_mfma_f32_16x16x32_bf16 v[192:195], v[96:99], v[56:59], v[192:195]
    ds_read2_b32 v[134:135], v16 offset0:192 offset1:224
    v_mfma_f32_16x16x32_bf16 v[208:211], v[96:99], v[60:63], v[208:211]
    v_add_u32 v16, 118784, v14
    v_mfma_f32_16x16x32_bf16 v[224:227], v[96:99], v[64:67], v[224:227]
    ds_read2_b32 v[144:145], v16 offset0:0 offset1:32
    v_mfma_f32_16x16x32_bf16 v[240:243], v[96:99], v[68:71], v[240:243]
    ds_read2_b32 v[146:147], v16 offset0:64 offset1:96
    s_waitcnt lgkmcnt(0)
    s_barrier
    v_mfma_f32_16x16x32_bf16 v[196:199], v[100:103], v[56:59], v[196:199]
    ds_read_b128 v[40:43], v2 offset:40960
    v_mfma_f32_16x16x32_bf16 v[212:215], v[100:103], v[60:63], v[212:215]
    ds_read_b64_tr_b16 v[72:73], v6 offset:40960
    v_mfma_f32_16x16x32_bf16 v[228:231], v[100:103], v[64:67], v[228:231]
    ds_read_b64_tr_b16 v[74:75], v6 offset:41472
    v_mfma_f32_16x16x32_bf16 v[244:247], v[100:103], v[68:71], v[244:247]
    ds_read_b128 v[44:47], v2 offset:43008
    v_mfma_f32_16x16x32_bf16 v[200:203], v[104:107], v[56:59], v[200:203]
    ds_read_b128 v[48:51], v2 offset:45056
    v_mfma_f32_16x16x32_bf16 v[216:219], v[104:107], v[60:63], v[216:219]
    ds_read_b128 v[52:55], v2 offset:47104
    v_mfma_f32_16x16x32_bf16 v[232:235], v[104:107], v[64:67], v[232:235]
    ds_read_b64_tr_b16 v[76:77], v7 offset:40960
    v_mfma_f32_16x16x32_bf16 v[248:251], v[104:107], v[68:71], v[248:251]
    ds_read_b64_tr_b16 v[78:79], v7 offset:41472
    v_mfma_f32_16x16x32_bf16 v[204:207], v[108:111], v[56:59], v[204:207]
    ds_read_b64_tr_b16 v[80:81], v6 offset:43008
    v_mfma_f32_16x16x32_bf16 v[220:223], v[108:111], v[60:63], v[220:223]
    ds_read_b64_tr_b16 v[82:83], v6 offset:43520
    v_mfma_f32_16x16x32_bf16 v[236:239], v[108:111], v[64:67], v[236:239]
    ds_read_b64_tr_b16 v[84:85], v7 offset:43008
    v_mfma_f32_16x16x32_bf16 v[252:255], v[108:111], v[68:71], v[252:255]
    ds_read_b64_tr_b16 v[86:87], v7 offset:43520
    s_waitcnt lgkmcnt(4)
    v_mfma_f32_16x16x32_bf16 v[192:195], v[72:75], v[40:43], v[192:195]
    ds_read_b128 v[56:59], v3 offset:40960
    v_mfma_f32_16x16x32_bf16 v[208:211], v[72:75], v[44:47], v[208:211]
    ds_read_b64_tr_b16 v[96:97], v6 offset:49152
    v_mfma_f32_16x16x32_bf16 v[224:227], v[72:75], v[48:51], v[224:227]
    ds_read_b64_tr_b16 v[98:99], v6 offset:49664
    v_mfma_f32_16x16x32_bf16 v[240:243], v[72:75], v[52:55], v[240:243]
    ds_read_b128 v[60:63], v3 offset:43008
    v_mfma_f32_16x16x32_bf16 v[196:199], v[76:79], v[40:43], v[196:199]
    ds_read_b128 v[64:67], v3 offset:45056
    v_mfma_f32_16x16x32_bf16 v[212:215], v[76:79], v[44:47], v[212:215]
    ds_read_b128 v[68:71], v3 offset:47104
    v_mfma_f32_16x16x32_bf16 v[228:231], v[76:79], v[48:51], v[228:231]
    ds_read_b64_tr_b16 v[100:101], v7 offset:49152
    v_mfma_f32_16x16x32_bf16 v[244:247], v[76:79], v[52:55], v[244:247]
    ds_read_b64_tr_b16 v[102:103], v7 offset:49664
    s_waitcnt lgkmcnt(8)
    v_mfma_f32_16x16x32_bf16 v[200:203], v[80:83], v[40:43], v[200:203]
    ds_read_b64_tr_b16 v[104:105], v6 offset:51200
    v_mfma_f32_16x16x32_bf16 v[216:219], v[80:83], v[44:47], v[216:219]
    ds_read_b64_tr_b16 v[106:107], v6 offset:51712
    v_mfma_f32_16x16x32_bf16 v[232:235], v[80:83], v[48:51], v[232:235]
    ds_read_b64_tr_b16 v[108:109], v7 offset:51200
    v_mfma_f32_16x16x32_bf16 v[248:251], v[80:83], v[52:55], v[248:251]
    ds_read_b64_tr_b16 v[110:111], v7 offset:51712
    v_mfma_f32_16x16x32_bf16 v[204:207], v[84:87], v[40:43], v[204:207]
    ds_read2_b32 v[148:149], v16 offset0:128 offset1:160
    v_mfma_f32_16x16x32_bf16 v[220:223], v[84:87], v[44:47], v[220:223]
    ds_read2_b32 v[150:151], v16 offset0:192 offset1:224
    v_mfma_f32_16x16x32_bf16 v[236:239], v[84:87], v[48:51], v[236:239]
    v_add_f32 v128, v128, v129
    v_mfma_f32_16x16x32_bf16 v[252:255], v[84:87], v[52:55], v[252:255]
    v_add_f32 v130, v130, v131
    v_add_f32 v132, v132, v133
    s_waitcnt lgkmcnt(6)
    v_mfma_f32_16x16x32_bf16 v[192:195], v[96:99], v[56:59], v[192:195]
    v_add_f32 v134, v134, v135
    v_add_f32 v128, v128, v130
    v_mfma_f32_16x16x32_bf16 v[208:211], v[96:99], v[60:63], v[208:211]
    v_add_f32 v132, v132, v134
    v_add_f32 v128, v128, v132
    v_mfma_f32_16x16x32_bf16 v[224:227], v[96:99], v[64:67], v[224:227]
    v_mov_b32 v129, v128
    v_mfma_f32_16x16x32_bf16 v[240:243], v[96:99], v[68:71], v[240:243]
    s_nop 1
    v_mfma_f32_16x16x32_bf16 v[196:199], v[100:103], v[56:59], v[196:199]
    v_permlane32_swap_b32 v128, v129
    v_mfma_f32_16x16x32_bf16 v[212:215], v[100:103], v[60:63], v[212:215]
    v_add_f32 v128, v128, v129
    v_cvt_pk_bf16_f32 v129, v128, v128
    v_mfma_f32_16x16x32_bf16 v[228:231], v[100:103], v[64:67], v[228:231]
    v_and_b32 v129, 0xffff0000, v129
    v_sub_f32 v128, v128, v129
    v_mfma_f32_16x16x32_bf16 v[244:247], v[100:103], v[68:71], v[244:247]
    v_cvt_pk_bf16_f32 v128, v129, v128
    v_cndmask_b32 v130, 0, v128, s[94:95]
    s_waitcnt lgkmcnt(2)
    v_mfma_f32_16x16x32_bf16 v[200:203], v[104:107], v[56:59], v[200:203]
    v_cndmask_b32 v132, 0, v128, s[96:97]
    v_mov_b32 v131, v130
    v_mfma_f32_16x16x32_bf16 v[216:219], v[104:107], v[60:63], v[216:219]
    v_mov_b32 v133, v132
    s_waitcnt lgkmcnt(0)
    v_mfma_f32_16x16x32_bf16 v[232:235], v[104:107], v[64:67], v[232:235]
    v_add_f32 v144, v144, v145
    v_add_f32 v146, v146, v147
    v_mfma_f32_16x16x32_bf16 v[248:251], v[104:107], v[68:71], v[248:251]
    v_add_f32 v148, v148, v149
    v_add_f32 v150, v150, v151
    v_mfma_f32_16x16x32_bf16 v[204:207], v[108:111], v[56:59], v[204:207]
    v_add_f32 v144, v144, v146
    v_add_f32 v148, v148, v150
    v_mfma_f32_16x16x32_bf16 v[220:223], v[108:111], v[60:63], v[220:223]
    v_add_f32 v144, v144, v148
    v_mov_b32 v145, v144
    v_mfma_f32_16x16x32_bf16 v[236:239], v[108:111], v[64:67], v[236:239]
    s_nop 1
    v_mfma_f32_16x16x32_bf16 v[252:255], v[108:111], v[68:71], v[252:255]
    v_permlane32_swap_b32 v144, v145
    v_add_f32 v144, v144, v145
    v_cvt_pk_bf16_f32 v145, v144, v144
    v_and_b32 v145, 0xffff0000, v145
    v_sub_f32 v144, v144, v145
    v_cvt_pk_bf16_f32 v144, v145, v144
    v_cndmask_b32 v146, 0, v144, s[94:95]
    v_cndmask_b32 v148, 0, v144, s[96:97]
    v_mov_b32 v147, v146
    v_mov_b32 v149, v148
    v_mul_u32_u24 v15, 2080, v17
    v_mov_b32 v112, 0x3f803f80
    v_mov_b32 v113, 0x3f803f80
    v_mov_b32 v114, 0x3f803f80
    v_mov_b32 v115, 0x3f803f80
    v_mov_b64 v[116:117], 0
    v_mov_b64 v[118:119], 0
    v_mfma_f32_16x16x16_bf16 v[192:195], v[130:131], v[20:21], v[192:195]
    v_mfma_f32_16x16x16_bf16 v[196:199], v[132:133], v[20:21], v[196:199]
    v_mfma_f32_16x16x16_bf16 v[200:203], v[146:147], v[20:21], v[200:203]
    v_mfma_f32_16x16x16_bf16 v[204:207], v[148:149], v[20:21], v[204:207]
    v_mfma_f32_16x16x16_bf16 v[208:211], v[130:131], v[24:25], v[208:211]
    v_mfma_f32_16x16x16_bf16 v[212:215], v[132:133], v[24:25], v[212:215]
    v_mfma_f32_16x16x16_bf16 v[216:219], v[146:147], v[24:25], v[216:219]
    v_mfma_f32_16x16x16_bf16 v[220:223], v[148:149], v[24:25], v[220:223]
    v_mfma_f32_16x16x16_bf16 v[224:227], v[130:131], v[28:29], v[224:227]
    v_mfma_f32_16x16x16_bf16 v[228:231], v[132:133], v[28:29], v[228:231]
    v_mfma_f32_16x16x16_bf16 v[232:235], v[146:147], v[28:29], v[232:235]
    v_mfma_f32_16x16x16_bf16 v[236:239], v[148:149], v[28:29], v[236:239]
    v_mfma_f32_16x16x16_bf16 v[240:243], v[130:131], v[32:33], v[240:243]
    v_mfma_f32_16x16x16_bf16 v[244:247], v[132:133], v[32:33], v[244:247]
    v_mfma_f32_16x16x16_bf16 v[248:251], v[146:147], v[32:33], v[248:251]
    v_mfma_f32_16x16x16_bf16 v[252:255], v[148:149], v[32:33], v[252:255]
    v_pk_mul_f32 v[40:41], v[192:193], v[120:121] op_sel_hi:[1,0]
    v_pk_mul_f32 v[42:43], v[194:195], v[120:121] op_sel_hi:[1,0]
    v_pk_mul_f32 v[44:45], v[196:197], v[120:121] op_sel_hi:[1,0]
    v_pk_mul_f32 v[46:47], v[198:199], v[120:121] op_sel_hi:[1,0]
    v_exp_f32 v40, v40
    v_exp_f32 v41, v41
    v_exp_f32 v42, v42
    v_exp_f32 v43, v43
    v_exp_f32 v44, v44
    v_exp_f32 v45, v45
    v_exp_f32 v46, v46
    v_exp_f32 v47, v47
    v_pk_mul_f32 v[192:193], v[192:193], v[200:201]
    v_pk_mul_f32 v[194:195], v[194:195], v[202:203]
    v_pk_mul_f32 v[196:197], v[196:197], v[204:205]
    v_pk_mul_f32 v[198:199], v[198:199], v[206:207]
    v_pk_fma_f32 v[40:41], v[40:41], v[22:23], v[22:23] op_sel:[0,1,1] op_sel_hi:[1,1,1]
    v_pk_fma_f32 v[42:43], v[42:43], v[22:23], v[22:23] op_sel:[0,1,1] op_sel_hi:[1,1,1]
    v_pk_fma_f32 v[44:45], v[44:45], v[22:23], v[22:23] op_sel:[0,1,1] op_sel_hi:[1,1,1]
    v_pk_fma_f32 v[46:47], v[46:47], v[22:23], v[22:23] op_sel:[0,1,1] op_sel_hi:[1,1,1]
    v_rcp_f32 v40, v40
    v_rcp_f32 v41, v41
    v_rcp_f32 v42, v42
    v_rcp_f32 v43, v43
    v_rcp_f32 v44, v44
    v_rcp_f32 v45, v45
    v_rcp_f32 v46, v46
    v_rcp_f32 v47, v47
    s_nop 0
    v_pk_mul_f32 v[192:193], v[192:193], v[40:41]
    v_pk_mul_f32 v[194:195], v[194:195], v[42:43]
    v_pk_mul_f32 v[196:197], v[196:197], v[44:45]
    v_pk_mul_f32 v[198:199], v[198:199], v[46:47]
    v_cvt_pk_bf16_f32 v200, v192, v193
    v_cvt_pk_bf16_f32 v201, v194, v195
    v_cvt_pk_bf16_f32 v202, v196, v197
    v_cvt_pk_bf16_f32 v203, v198, v199
    buffer_store_dwordx4 v[200:203], v8, s[24:27], s86 offen offset:0 sc1
    v_pk_mul_f32 v[48:49], v[208:209], v[122:123] op_sel_hi:[1,0]
    v_pk_mul_f32 v[50:51], v[210:211], v[122:123] op_sel_hi:[1,0]
    v_pk_mul_f32 v[52:53], v[212:213], v[122:123] op_sel_hi:[1,0]
    v_pk_mul_f32 v[54:55], v[214:215], v[122:123] op_sel_hi:[1,0]
    v_exp_f32 v48, v48
    v_exp_f32 v49, v49
    v_exp_f32 v50, v50
    v_exp_f32 v51, v51
    v_exp_f32 v52, v52
    v_exp_f32 v53, v53
    v_exp_f32 v54, v54
    v_exp_f32 v55, v55
    v_pk_mul_f32 v[208:209], v[208:209], v[216:217]
    v_pk_mul_f32 v[210:211], v[210:211], v[218:219]
    v_pk_mul_f32 v[212:213], v[212:213], v[220:221]
    v_pk_mul_f32 v[214:215], v[214:215], v[222:223]
    v_pk_fma_f32 v[48:49], v[48:49], v[26:27], v[26:27] op_sel:[0,1,1] op_sel_hi:[1,1,1]
    v_pk_fma_f32 v[50:51], v[50:51], v[26:27], v[26:27] op_sel:[0,1,1] op_sel_hi:[1,1,1]
    v_pk_fma_f32 v[52:53], v[52:53], v[26:27], v[26:27] op_sel:[0,1,1] op_sel_hi:[1,1,1]
    v_pk_fma_f32 v[54:55], v[54:55], v[26:27], v[26:27] op_sel:[0,1,1] op_sel_hi:[1,1,1]
    v_rcp_f32 v48, v48
    v_rcp_f32 v49, v49
    v_rcp_f32 v50, v50
    v_rcp_f32 v51, v51
    v_rcp_f32 v52, v52
    v_rcp_f32 v53, v53
    v_rcp_f32 v54, v54
    v_rcp_f32 v55, v55
    s_nop 0
    v_pk_mul_f32 v[208:209], v[208:209], v[48:49]
    v_pk_mul_f32 v[210:211], v[210:211], v[50:51]
    v_pk_mul_f32 v[212:213], v[212:213], v[52:53]
    v_pk_mul_f32 v[214:215], v[214:215], v[54:55]
    v_cvt_pk_bf16_f32 v216, v208, v209
    v_cvt_pk_bf16_f32 v217, v210, v211
    v_cvt_pk_bf16_f32 v218, v212, v213
    v_cvt_pk_bf16_f32 v219, v214, v215
    buffer_store_dwordx4 v[216:219], v8, s[24:27], s86 offen offset:256 sc1
    s_mov_b32 s70, 0
    s_waitcnt lgkmcnt(0)
    s_barrier
    ds_read_b128 v[40:43], v18
    ds_read_b128 v[80:83], v19
    ds_read_b128 v[44:47], v18 offset:1024
    ds_write_b128 v15, v[112:115] offset:2048
    ds_write_b128 v15, v[116:119] offset:2064
    s_waitcnt lgkmcnt(3)
    v_mfma_f32_32x32x16_bf16 v[48:63], v[80:83], v[40:43], 0
    s_waitcnt lgkmcnt(2)
    v_mfma_f32_32x32x16_bf16 v[64:79], v[80:83], v[44:47], 0
    buffer_store_dwordx4 v[136:139], v8, s[24:27], s82 offen offset:0 sc1
    buffer_store_dwordx4 v[152:155], v8, s[24:27], s82 offen offset:256 sc1
    buffer_store_dwordx4 v[168:171], v8, s[24:27], s83 offen offset:0 sc1
    buffer_store_dwordx4 v[184:187], v8, s[24:27], s83 offen offset:256 sc1
    v_pk_mul_f32 v[128:129], v[224:225], v[124:125] op_sel_hi:[1,0]
    v_pk_mul_f32 v[130:131], v[226:227], v[124:125] op_sel_hi:[1,0]
    v_pk_mul_f32 v[132:133], v[228:229], v[124:125] op_sel_hi:[1,0]
    v_pk_mul_f32 v[134:135], v[230:231], v[124:125] op_sel_hi:[1,0]
    v_exp_f32 v128, v128
    v_exp_f32 v129, v129
    v_exp_f32 v130, v130
    v_exp_f32 v131, v131
    v_exp_f32 v132, v132
    v_exp_f32 v133, v133
    v_exp_f32 v134, v134
    v_exp_f32 v135, v135
    v_pk_mul_f32 v[224:225], v[224:225], v[232:233]
    v_pk_mul_f32 v[226:227], v[226:227], v[234:235]
    v_pk_mul_f32 v[228:229], v[228:229], v[236:237]
    v_pk_mul_f32 v[230:231], v[230:231], v[238:239]
    v_pk_fma_f32 v[128:129], v[128:129], v[30:31], v[30:31] op_sel:[0,1,1] op_sel_hi:[1,1,1]
    v_pk_fma_f32 v[130:131], v[130:131], v[30:31], v[30:31] op_sel:[0,1,1] op_sel_hi:[1,1,1]
    v_pk_fma_f32 v[132:133], v[132:133], v[30:31], v[30:31] op_sel:[0,1,1] op_sel_hi:[1,1,1]
    v_pk_fma_f32 v[134:135], v[134:135], v[30:31], v[30:31] op_sel:[0,1,1] op_sel_hi:[1,1,1]
    v_rcp_f32 v128, v128
    v_rcp_f32 v129, v129
    v_rcp_f32 v130, v130
    v_rcp_f32 v131, v131
    v_rcp_f32 v132, v132
    v_rcp_f32 v133, v133
    v_rcp_f32 v134, v134
    v_rcp_f32 v135, v135
    s_nop 0
    v_pk_mul_f32 v[224:225], v[224:225], v[128:129]
    v_pk_mul_f32 v[226:227], v[226:227], v[130:131]
    v_pk_mul_f32 v[228:229], v[228:229], v[132:133]
    v_pk_mul_f32 v[230:231], v[230:231], v[134:135]
    v_cvt_pk_bf16_f32 v232, v224, v225
    v_cvt_pk_bf16_f32 v233, v226, v227
    v_cvt_pk_bf16_f32 v234, v228, v229
    v_cvt_pk_bf16_f32 v235, v230, v231
    buffer_store_dwordx4 v[232:235], v8, s[24:27], s87 offen offset:0 sc1
    v_pk_mul_f32 v[136:137], v[240:241], v[126:127] op_sel_hi:[1,0]
    v_pk_mul_f32 v[138:139], v[242:243], v[126:127] op_sel_hi:[1,0]
    v_pk_mul_f32 v[140:141], v[244:245], v[126:127] op_sel_hi:[1,0]
    v_pk_mul_f32 v[142:143], v[246:247], v[126:127] op_sel_hi:[1,0]
    v_exp_f32 v136, v136
    v_exp_f32 v137, v137
    v_exp_f32 v138, v138
    v_exp_f32 v139, v139
    v_exp_f32 v140, v140
    v_exp_f32 v141, v141
    v_exp_f32 v142, v142
    v_exp_f32 v143, v143
    v_pk_mul_f32 v[240:241], v[240:241], v[248:249]
    v_pk_mul_f32 v[242:243], v[242:243], v[250:251]
    v_pk_mul_f32 v[244:245], v[244:245], v[252:253]
    v_pk_mul_f32 v[246:247], v[246:247], v[254:255]
    v_pk_fma_f32 v[136:137], v[136:137], v[34:35], v[34:35] op_sel:[0,1,1] op_sel_hi:[1,1,1]
    v_pk_fma_f32 v[138:139], v[138:139], v[34:35], v[34:35] op_sel:[0,1,1] op_sel_hi:[1,1,1]
    v_pk_fma_f32 v[140:141], v[140:141], v[34:35], v[34:35] op_sel:[0,1,1] op_sel_hi:[1,1,1]
    v_pk_fma_f32 v[142:143], v[142:143], v[34:35], v[34:35] op_sel:[0,1,1] op_sel_hi:[1,1,1]
    v_rcp_f32 v136, v136
    v_rcp_f32 v137, v137
    v_rcp_f32 v138, v138
    v_rcp_f32 v139, v139
    v_rcp_f32 v140, v140
    v_rcp_f32 v141, v141
    v_rcp_f32 v142, v142
    v_rcp_f32 v143, v143
    s_nop 0
    v_pk_mul_f32 v[240:241], v[240:241], v[136:137]
    v_pk_mul_f32 v[242:243], v[242:243], v[138:139]
    v_pk_mul_f32 v[244:245], v[244:245], v[140:141]
    v_pk_mul_f32 v[246:247], v[246:247], v[142:143]
    v_cvt_pk_bf16_f32 v248, v240, v241
    v_cvt_pk_bf16_f32 v249, v242, v243
    v_cvt_pk_bf16_f32 v250, v244, v245
    v_cvt_pk_bf16_f32 v251, v246, v247
    buffer_store_dwordx4 v[248:251], v8, s[24:27], s87 offen offset:256 sc1
    v_max3_f32 v5, v48, v49, v50
    v_max3_f32 v5, v5, v51, v52
    v_max3_f32 v5, v5, v53, v54
    v_max3_f32 v5, v5, v55, v56
    v_max3_f32 v5, v5, v57, v58
    v_max3_f32 v5, v5, v59, v60
    v_max3_f32 v5, v5, v61, v62
    v_max_f32 v5, v5, v63
    v_max3_f32 v6, v64, v65, v66
    v_max3_f32 v6, v6, v67, v68
    v_max3_f32 v6, v6, v69, v70
    v_max3_f32 v6, v6, v71, v72
    v_max3_f32 v6, v6, v73, v74
    v_max3_f32 v6, v6, v75, v76
    v_max3_f32 v6, v6, v77, v78
    v_max_f32 v6, v6, v79
    s_mov_b32 s75, 2
L_SETC:
    v_mov_b32 v2, v19
    v_mov_b32 v3, v0
    v_mov_b32 v4, v1
    ds_read_b128 v[80:83], v2
    ds_read_b128 v[100:103], v4
    ds_read_b128 v[88:91], v3
    ds_read_b128 v[92:95], v4
    v_mov_b32 v15, v5
    v_mov_b32 v16, v6
    s_nop 0
    v_permlane32_swap_b32 v5, v15
    v_permlane32_swap_b32 v6, v16
    v_max_f32 v5, v5, v15
    v_max_f32 v6, v6, v16
    v_sub_f32 v128, 0, v5
    v_sub_f32 v129, 0, v5
    v_mov_b64 v[130:131], v[128:129]
    v_mov_b64 v[132:133], v[128:129]
    v_mov_b64 v[134:135], v[128:129]
    v_mov_b64 v[136:137], v[128:129]
    v_mov_b64 v[138:139], v[128:129]
    v_mov_b64 v[140:141], v[128:129]
    v_mov_b64 v[142:143], v[128:129]
    s_waitcnt lgkmcnt(2)
    s_nop 0
    v_mfma_f32_32x32x16_bf16 v[48:63], v[80:83], v[40:43], v[128:143]
    v_sub_f32 v144, 0, v6
    v_sub_f32 v145, 0, v6
    v_mov_b64 v[146:147], v[144:145]
    v_mov_b64 v[148:149], v[144:145]
    v_mov_b64 v[150:151], v[144:145]
    v_mov_b64 v[152:153], v[144:145]
    v_mov_b64 v[154:155], v[144:145]
    v_mov_b64 v[156:157], v[144:145]
    v_mov_b64 v[158:159], v[144:145]
    v_mov_b64 v[160:161], 0
    v_mov_b64 v[176:177], 0
    v_mov_b64 v[162:163], 0
    v_mov_b64 v[178:179], 0
    v_mov_b64 v[164:165], 0
    v_mov_b64 v[180:181], 0
    v_mov_b64 v[166:167], 0
    v_mov_b64 v[182:183], 0
    v_mov_b64 v[168:169], 0
    v_mov_b64 v[184:185], 0
    v_mov_b64 v[170:171], 0
    v_mov_b64 v[186:187], 0
    v_mov_b64 v[172:173], 0
    v_mov_b64 v[188:189], 0
    v_mov_b64 v[174:175], 0
    v_mov_b64 v[190:191], 0
    v_mov_b64 v[108:109], 0
    v_mov_b64 v[110:111], 0
    s_mov_b32 s71, 0
.p2align 6
L_BLOOP:
    v_exp_f32 v48, v48
    v_exp_f32 v49, v49
    v_exp_f32 v50, v50
    v_exp_f32 v51, v51
    v_mfma_f32_32x32x16_bf16 v[176:191], v[100:103], v[108:111], v[176:191]
    ds_read_b128 v[84:87], v2 offset:2080
    v_exp_f32 v52, v52
    v_exp_f32 v53, v53
    v_exp_f32 v54, v54
    v_exp_f32 v55, v55
    v_mfma_f32_32x32x16_bf16 v[64:79], v[80:83], v[44:47], v[144:159]
    s_waitcnt lgkmcnt(1)
    v_cvt_pk_bf16_f32 v104, v48, v49
    v_cvt_pk_bf16_f32 v105, v50, v51
    v_cvt_pk_bf16_f32 v106, v52, v53
    v_cvt_pk_bf16_f32 v107, v54, v55
    v_exp_f32 v56, v56
    v_exp_f32 v57, v57
    v_mfma_f32_32x32x16_bf16 v[160:175], v[88:91], v[104:107], v[160:175]
    ds_read_b128 v[96:99], v3 offset:2080
    v_exp_f32 v58, v58
    v_exp_f32 v59, v59
    v_exp_f32 v60, v60
    v_exp_f32 v61, v61
    v_exp_f32 v62, v62
    v_exp_f32 v63, v63
    v_cvt_pk_bf16_f32 v108, v56, v57
    v_cvt_pk_bf16_f32 v109, v58, v59
    v_cvt_pk_bf16_f32 v110, v60, v61
    v_cvt_pk_bf16_f32 v111, v62, v63
    v_exp_f32 v64, v64
    v_exp_f32 v65, v65
    v_exp_f32 v66, v66
    v_exp_f32 v67, v67
    v_mfma_f32_32x32x16_bf16 v[160:175], v[92:95], v[108:111], v[160:175]
    s_waitcnt lgkmcnt(1)
    v_exp_f32 v68, v68
    v_exp_f32 v69, v69
    v_exp_f32 v70, v70
    v_exp_f32 v71, v71
    v_mfma_f32_32x32x16_bf16 v[48:63], v[84:87], v[40:43], v[128:143]
    ds_read_b128 v[100:103], v4 offset:2080
    v_cvt_pk_bf16_f32 v104, v64, v65
    v_cvt_pk_bf16_f32 v105, v66, v67
    v_cvt_pk_bf16_f32 v106, v68, v69
    v_cvt_pk_bf16_f32 v107, v70, v71
    v_exp_f32 v72, v72
    v_exp_f32 v73, v73
    v_mfma_f32_32x32x16_bf16 v[176:191], v[88:91], v[104:107], v[176:191]
    v_exp_f32 v74, v74
    v_exp_f32 v75, v75
    v_exp_f32 v76, v76
    v_exp_f32 v77, v77
    v_exp_f32 v78, v78
    v_exp_f32 v79, v79
    v_cvt_pk_bf16_f32 v108, v72, v73
    v_cvt_pk_bf16_f32 v109, v74, v75
    v_cvt_pk_bf16_f32 v110, v76, v77
    v_cvt_pk_bf16_f32 v111, v78, v79
    v_exp_f32 v48, v48
    v_exp_f32 v49, v49
    v_exp_f32 v50, v50
    v_exp_f32 v51, v51
    v_mfma_f32_32x32x16_bf16 v[176:191], v[92:95], v[108:111], v[176:191]
    ds_read_b128 v[80:83], v2 offset:4160
    v_exp_f32 v52, v52
    v_exp_f32 v53, v53
    v_exp_f32 v54, v54
    v_exp_f32 v55, v55
    v_mfma_f32_32x32x16_bf16 v[64:79], v[84:87], v[44:47], v[144:159]
    s_waitcnt lgkmcnt(1)
    v_cvt_pk_bf16_f32 v104, v48, v49
    v_cvt_pk_bf16_f32 v105, v50, v51
    v_cvt_pk_bf16_f32 v106, v52, v53
    v_cvt_pk_bf16_f32 v107, v54, v55
    v_exp_f32 v56, v56
    v_exp_f32 v57, v57
    v_mfma_f32_32x32x16_bf16 v[160:175], v[96:99], v[104:107], v[160:175]
    ds_read_b128 v[88:91], v3 offset:4160
    v_exp_f32 v58, v58
    v_exp_f32 v59, v59
    v_exp_f32 v60, v60
    v_exp_f32 v61, v61
    v_exp_f32 v62, v62
    v_exp_f32 v63, v63
    v_cvt_pk_bf16_f32 v108, v56, v57
    v_cvt_pk_bf16_f32 v109, v58, v59
    v_cvt_pk_bf16_f32 v110, v60, v61
    v_cvt_pk_bf16_f32 v111, v62, v63
    v_exp_f32 v64, v64
    v_exp_f32 v65, v65
    v_exp_f32 v66, v66
    v_exp_f32 v67, v67
    v_mfma_f32_32x32x16_bf16 v[160:175], v[100:103], v[108:111], v[160:175]
    s_waitcnt lgkmcnt(1)
    v_exp_f32 v68, v68
    v_exp_f32 v69, v69
    v_exp_f32 v70, v70
    v_exp_f32 v71, v71
    v_mfma_f32_32x32x16_bf16 v[48:63], v[80:83], v[40:43], v[128:143]
    ds_read_b128 v[92:95], v4 offset:4160
    v_cvt_pk_bf16_f32 v104, v64, v65
    v_cvt_pk_bf16_f32 v105, v66, v67
    v_cvt_pk_bf16_f32 v106, v68, v69
    v_cvt_pk_bf16_f32 v107, v70, v71
    v_exp_f32 v72, v72
    v_exp_f32 v73, v73
    v_mfma_f32_32x32x16_bf16 v[176:191], v[96:99], v[104:107], v[176:191]
    v_exp_f32 v74, v74
    v_exp_f32 v75, v75
    v_exp_f32 v76, v76
    v_exp_f32 v77, v77
    v_exp_f32 v78, v78
    v_exp_f32 v79, v79
    v_cvt_pk_bf16_f32 v108, v72, v73
    v_cvt_pk_bf16_f32 v109, v74, v75
    v_cvt_pk_bf16_f32 v110, v76, v77
    v_cvt_pk_bf16_f32 v111, v78, v79
    v_exp_f32 v48, v48
    v_exp_f32 v49, v49
    v_exp_f32 v50, v50
    v_exp_f32 v51, v51
    v_mfma_f32_32x32x16_bf16 v[176:191], v[100:103], v[108:111], v[176:191]
    ds_read_b128 v[84:87], v2 offset:6240
    v_exp_f32 v52, v52
    v_exp_f32 v53, v53
    v_exp_f32 v54, v54
    v_exp_f32 v55, v55
    v_mfma_f32_32x32x16_bf16 v[64:79], v[80:83], v[44:47], v[144:159]
    s_waitcnt lgkmcnt(1)
    v_cvt_pk_bf16_f32 v104, v48, v49
    v_cvt_pk_bf16_f32 v105, v50, v51
    v_cvt_pk_bf16_f32 v106, v52, v53
    v_cvt_pk_bf16_f32 v107, v54, v55
    v_exp_f32 v56, v56
    v_exp_f32 v57, v57
    v_mfma_f32_32x32x16_bf16 v[160:175], v[88:91], v[104:107], v[160:175]
    ds_read_b128 v[96:99], v3 offset:6240
    v_exp_f32 v58, v58
    v_exp_f32 v59, v59
    v_exp_f32 v60, v60
    v_exp_f32 v61, v61
    v_exp_f32 v62, v62
    v_exp_f32 v63, v63
    v_cvt_pk_bf16_f32 v108, v56, v57
    v_cvt_pk_bf16_f32 v109, v58, v59
    v_cvt_pk_bf16_f32 v110, v60, v61
    v_cvt_pk_bf16_f32 v111, v62, v63
    v_exp_f32 v64, v64
    v_exp_f32 v65, v65
    v_exp_f32 v66, v66
    v_exp_f32 v67, v67
    v_mfma_f32_32x32x16_bf16 v[160:175], v[92:95], v[108:111], v[160:175]
    s_waitcnt lgkmcnt(1)
    v_exp_f32 v68, v68
    v_exp_f32 v69, v69
    v_exp_f32 v70, v70
    v_exp_f32 v71, v71
    v_mfma_f32_32x32x16_bf16 v[48:63], v[84:87], v[40:43], v[128:143]
    ds_read_b128 v[100:103], v4 offset:6240
    v_cvt_pk_bf16_f32 v104, v64, v65
    v_cvt_pk_bf16_f32 v105, v66, v67
    v_cvt_pk_bf16_f32 v106, v68, v69
    v_cvt_pk_bf16_f32 v107, v70, v71
    v_exp_f32 v72, v72
    v_exp_f32 v73, v73
    v_mfma_f32_32x32x16_bf16 v[176:191], v[88:91], v[104:107], v[176:191]
    v_exp_f32 v74, v74
    v_exp_f32 v75, v75
    v_exp_f32 v76, v76
    v_exp_f32 v77, v77
    v_exp_f32 v78, v78
    v_exp_f32 v79, v79
    v_cvt_pk_bf16_f32 v108, v72, v73
    v_cvt_pk_bf16_f32 v109, v74, v75
    v_cvt_pk_bf16_f32 v110, v76, v77
    v_cvt_pk_bf16_f32 v111, v78, v79
    v_exp_f32 v48, v48
    v_exp_f32 v49, v49
    v_exp_f32 v50, v50
    v_exp_f32 v51, v51
    v_mfma_f32_32x32x16_bf16 v[176:191], v[92:95], v[108:111], v[176:191]
    ds_read_b128 v[80:83], v2 offset:8320
    v_exp_f32 v52, v52
    v_exp_f32 v53, v53
    v_exp_f32 v54, v54
    v_exp_f32 v55, v55
    v_mfma_f32_32x32x16_bf16 v[64:79], v[84:87], v[44:47], v[144:159]
    s_waitcnt lgkmcnt(1)
    v_cvt_pk_bf16_f32 v104, v48, v49
    v_cvt_pk_bf16_f32 v105, v50, v51
    v_cvt_pk_bf16_f32 v106, v52, v53
    v_cvt_pk_bf16_f32 v107, v54, v55
    v_exp_f32 v56, v56
    v_exp_f32 v57, v57
    v_mfma_f32_32x32x16_bf16 v[160:175], v[96:99], v[104:107], v[160:175]
    ds_read_b128 v[88:91], v3 offset:8320
    v_exp_f32 v58, v58
    v_exp_f32 v59, v59
    v_exp_f32 v60, v60
    v_exp_f32 v61, v61
    v_exp_f32 v62, v62
    v_exp_f32 v63, v63
    v_cvt_pk_bf16_f32 v108, v56, v57
    v_cvt_pk_bf16_f32 v109, v58, v59
    v_cvt_pk_bf16_f32 v110, v60, v61
    v_cvt_pk_bf16_f32 v111, v62, v63
    v_exp_f32 v64, v64
    v_exp_f32 v65, v65
    v_exp_f32 v66, v66
    v_exp_f32 v67, v67
    v_mfma_f32_32x32x16_bf16 v[160:175], v[100:103], v[108:111], v[160:175]
    s_waitcnt lgkmcnt(1)
    v_exp_f32 v68, v68
    v_exp_f32 v69, v69
    v_exp_f32 v70, v70
    v_exp_f32 v71, v71
    v_mfma_f32_32x32x16_bf16 v[48:63], v[80:83], v[40:43], v[128:143]
    ds_read_b128 v[92:95], v4 offset:8320
    v_cvt_pk_bf16_f32 v104, v64, v65
    v_cvt_pk_bf16_f32 v105, v66, v67
    v_cvt_pk_bf16_f32 v106, v68, v69
    v_cvt_pk_bf16_f32 v107, v70, v71
    v_exp_f32 v72, v72
    v_exp_f32 v73, v73
    v_mfma_f32_32x32x16_bf16 v[176:191], v[96:99], v[104:107], v[176:191]
    v_exp_f32 v74, v74
    v_exp_f32 v75, v75
    v_exp_f32 v76, v76
    v_exp_f32 v77, v77
    v_exp_f32 v78, v78
    v_exp_f32 v79, v79
    v_cvt_pk_bf16_f32 v108, v72, v73
    v_cvt_pk_bf16_f32 v109, v74, v75
    v_cvt_pk_bf16_f32 v110, v76, v77
    v_cvt_pk_bf16_f32 v111, v78, v79
    v_exp_f32 v48, v48
    v_exp_f32 v49, v49
    v_exp_f32 v50, v50
    v_exp_f32 v51, v51
    v_mfma_f32_32x32x16_bf16 v[176:191], v[100:103], v[108:111], v[176:191]
    ds_read_b128 v[84:87], v2 offset:10400
    v_exp_f32 v52, v52
    v_exp_f32 v53, v53
    v_exp_f32 v54, v54
    v_exp_f32 v55, v55
    v_mfma_f32_32x32x16_bf16 v[64:79], v[80:83], v[44:47], v[144:159]
    s_waitcnt lgkmcnt(1)
    v_cvt_pk_bf16_f32 v104, v48, v49
    v_cvt_pk_bf16_f32 v105, v50, v51
    v_cvt_pk_bf16_f32 v106, v52, v53
    v_cvt_pk_bf16_f32 v107, v54, v55
    v_exp_f32 v56, v56
    v_exp_f32 v57, v57
    v_mfma_f32_32x32x16_bf16 v[160:175], v[88:91], v[104:107], v[160:175]
    ds_read_b128 v[96:99], v3 offset:10400
    v_exp_f32 v58, v58
    v_exp_f32 v59, v59
    v_exp_f32 v60, v60
    v_exp_f32 v61, v61
    v_exp_f32 v62, v62
    v_exp_f32 v63, v63
    v_cvt_pk_bf16_f32 v108, v56, v57
    v_cvt_pk_bf16_f32 v109, v58, v59
    v_cvt_pk_bf16_f32 v110, v60, v61
    v_cvt_pk_bf16_f32 v111, v62, v63
    v_exp_f32 v64, v64
    v_exp_f32 v65, v65
    v_exp_f32 v66, v66
    v_exp_f32 v67, v67
    v_mfma_f32_32x32x16_bf16 v[160:175], v[92:95], v[108:111], v[160:175]
    s_waitcnt lgkmcnt(1)
    v_exp_f32 v68, v68
    v_exp_f32 v69, v69
    v_exp_f32 v70, v70
    v_exp_f32 v71, v71
    v_mfma_f32_32x32x16_bf16 v[48:63], v[84:87], v[40:43], v[128:143]
    ds_read_b128 v[100:103], v4 offset:10400
    v_cvt_pk_bf16_f32 v104, v64, v65
    v_cvt_pk_bf16_f32 v105, v66, v67
    v_cvt_pk_bf16_f32 v106, v68, v69
    v_cvt_pk_bf16_f32 v107, v70, v71
    v_exp_f32 v72, v72
    v_exp_f32 v73, v73
    v_mfma_f32_32x32x16_bf16 v[176:191], v[88:91], v[104:107], v[176:191]
    v_exp_f32 v74, v74
    v_exp_f32 v75, v75
    v_exp_f32 v76, v76
    v_exp_f32 v77, v77
    v_exp_f32 v78, v78
    v_exp_f32 v79, v79
    v_cvt_pk_bf16_f32 v108, v72, v73
    v_cvt_pk_bf16_f32 v109, v74, v75
    v_cvt_pk_bf16_f32 v110, v76, v77
    v_cvt_pk_bf16_f32 v111, v78, v79
    v_exp_f32 v48, v48
    v_exp_f32 v49, v49
    v_exp_f32 v50, v50
    v_exp_f32 v51, v51
    v_mfma_f32_32x32x16_bf16 v[176:191], v[92:95], v[108:111], v[176:191]
    ds_read_b128 v[80:83], v2 offset:12480
    v_exp_f32 v52, v52
    v_exp_f32 v53, v53
    v_exp_f32 v54, v54
    v_exp_f32 v55, v55
    v_mfma_f32_32x32x16_bf16 v[64:79], v[84:87], v[44:47], v[144:159]
    s_waitcnt lgkmcnt(1)
    v_cvt_pk_bf16_f32 v104, v48, v49
    v_cvt_pk_bf16_f32 v105, v50, v51
    v_cvt_pk_bf16_f32 v106, v52, v53
    v_cvt_pk_bf16_f32 v107, v54, v55
    v_exp_f32 v56, v56
    v_exp_f32 v57, v57
    v_mfma_f32_32x32x16_bf16 v[160:175], v[96:99], v[104:107], v[160:175]
    ds_read_b128 v[88:91], v3 offset:12480
    v_exp_f32 v58, v58
    v_exp_f32 v59, v59
    v_exp_f32 v60, v60
    v_exp_f32 v61, v61
    v_exp_f32 v62, v62
    v_exp_f32 v63, v63
    v_cvt_pk_bf16_f32 v108, v56, v57
    v_cvt_pk_bf16_f32 v109, v58, v59
    v_cvt_pk_bf16_f32 v110, v60, v61
    v_cvt_pk_bf16_f32 v111, v62, v63
    v_exp_f32 v64, v64
    v_exp_f32 v65, v65
    v_exp_f32 v66, v66
    v_exp_f32 v67, v67
    v_mfma_f32_32x32x16_bf16 v[160:175], v[100:103], v[108:111], v[160:175]
    s_waitcnt lgkmcnt(1)
    v_exp_f32 v68, v68
    v_exp_f32 v69, v69
    v_exp_f32 v70, v70
    v_exp_f32 v71, v71
    v_mfma_f32_32x32x16_bf16 v[48:63], v[80:83], v[40:43], v[128:143]
    ds_read_b128 v[92:95], v4 offset:12480
    v_cvt_pk_bf16_f32 v104, v64, v65
    v_cvt_pk_bf16_f32 v105, v66, v67
    v_cvt_pk_bf16_f32 v106, v68, v69
    v_cvt_pk_bf16_f32 v107, v70, v71
    v_exp_f32 v72, v72
    v_exp_f32 v73, v73
    v_mfma_f32_32x32x16_bf16 v[176:191], v[96:99], v[104:107], v[176:191]
    v_exp_f32 v74, v74
    v_exp_f32 v75, v75
    v_exp_f32 v76, v76
    v_exp_f32 v77, v77
    v_exp_f32 v78, v78
    v_exp_f32 v79, v79
    v_cvt_pk_bf16_f32 v108, v72, v73
    v_cvt_pk_bf16_f32 v109, v74, v75
    v_cvt_pk_bf16_f32 v110, v76, v77
    v_cvt_pk_bf16_f32 v111, v78, v79
    v_exp_f32 v48, v48
    v_exp_f32 v49, v49
    v_exp_f32 v50, v50
    v_exp_f32 v51, v51
    v_mfma_f32_32x32x16_bf16 v[176:191], v[100:103], v[108:111], v[176:191]
    ds_read_b128 v[84:87], v2 offset:14560
    v_exp_f32 v52, v52
    v_exp_f32 v53, v53
    v_exp_f32 v54, v54
    v_exp_f32 v55, v55
    v_mfma_f32_32x32x16_bf16 v[64:79], v[80:83], v[44:47], v[144:159]
    s_waitcnt lgkmcnt(1)
    v_cvt_pk_bf16_f32 v104, v48, v49
    v_cvt_pk_bf16_f32 v105, v50, v51
    v_cvt_pk_bf16_f32 v106, v52, v53
    v_cvt_pk_bf16_f32 v107, v54, v55
    v_exp_f32 v56, v56
    v_exp_f32 v57, v57
    v_mfma_f32_32x32x16_bf16 v[160:175], v[88:91], v[104:107], v[160:175]
    ds_read_b128 v[96:99], v3 offset:14560
    v_exp_f32 v58, v58
    v_exp_f32 v59, v59
    v_exp_f32 v60, v60
    v_exp_f32 v61, v61
    v_exp_f32 v62, v62
    v_exp_f32 v63, v63
    v_cvt_pk_bf16_f32 v108, v56, v57
    v_cvt_pk_bf16_f32 v109, v58, v59
    v_cvt_pk_bf16_f32 v110, v60, v61
    v_cvt_pk_bf16_f32 v111, v62, v63
    v_exp_f32 v64, v64
    v_exp_f32 v65, v65
    v_exp_f32 v66, v66
    v_exp_f32 v67, v67
    v_mfma_f32_32x32x16_bf16 v[160:175], v[92:95], v[108:111], v[160:175]
    s_waitcnt lgkmcnt(1)
    v_exp_f32 v68, v68
    v_exp_f32 v69, v69
    v_exp_f32 v70, v70
    v_exp_f32 v71, v71
    v_mfma_f32_32x32x16_bf16 v[48:63], v[84:87], v[40:43], v[128:143]
    ds_read_b128 v[100:103], v4 offset:14560
    v_cvt_pk_bf16_f32 v104, v64, v65
    v_cvt_pk_bf16_f32 v105, v66, v67
    v_cvt_pk_bf16_f32 v106, v68, v69
    v_cvt_pk_bf16_f32 v107, v70, v71
    v_exp_f32 v72, v72
    v_exp_f32 v73, v73
    v_mfma_f32_32x32x16_bf16 v[176:191], v[88:91], v[104:107], v[176:191]
    s_add_u32 s71, s71, 2
    v_exp_f32 v74, v74
    v_exp_f32 v75, v75
    v_exp_f32 v76, v76
    v_exp_f32 v77, v77
    v_exp_f32 v78, v78
    v_exp_f32 v79, v79
    v_cvt_pk_bf16_f32 v108, v72, v73
    v_cvt_pk_bf16_f32 v109, v74, v75
    v_cvt_pk_bf16_f32 v110, v76, v77
    v_cvt_pk_bf16_f32 v111, v78, v79
    v_exp_f32 v48, v48
    v_exp_f32 v49, v49
    v_exp_f32 v50, v50
    v_exp_f32 v51, v51
    v_mfma_f32_32x32x16_bf16 v[176:191], v[92:95], v[108:111], v[176:191]
    ds_read_b128 v[80:83], v2 offset:16640
    v_exp_f32 v52, v52
    v_exp_f32 v53, v53
    v_exp_f32 v54, v54
    v_exp_f32 v55, v55
    v_mfma_f32_32x32x16_bf16 v[64:79], v[84:87], v[44:47], v[144:159]
    s_waitcnt lgkmcnt(1)
    v_cvt_pk_bf16_f32 v104, v48, v49
    v_cvt_pk_bf16_f32 v105, v50, v51
    v_cvt_pk_bf16_f32 v106, v52, v53
    v_cvt_pk_bf16_f32 v107, v54, v55
    v_exp_f32 v56, v56
    v_exp_f32 v57, v57
    v_mfma_f32_32x32x16_bf16 v[160:175], v[96:99], v[104:107], v[160:175]
    ds_read_b128 v[88:91], v3 offset:16640
    v_exp_f32 v58, v58
    v_exp_f32 v59, v59
    v_exp_f32 v60, v60
    v_exp_f32 v61, v61
    v_exp_f32 v62, v62
    v_exp_f32 v63, v63
    v_cvt_pk_bf16_f32 v108, v56, v57
    v_cvt_pk_bf16_f32 v109, v58, v59
    v_cvt_pk_bf16_f32 v110, v60, v61
    v_cvt_pk_bf16_f32 v111, v62, v63
    v_exp_f32 v64, v64
    v_exp_f32 v65, v65
    v_exp_f32 v66, v66
    v_exp_f32 v67, v67
    v_mfma_f32_32x32x16_bf16 v[160:175], v[100:103], v[108:111], v[160:175]
    s_waitcnt lgkmcnt(1)
    v_exp_f32 v68, v68
    v_exp_f32 v69, v69
    v_exp_f32 v70, v70
    v_exp_f32 v71, v71
    v_mfma_f32_32x32x16_bf16 v[48:63], v[80:83], v[40:43], v[128:143]
    ds_read_b128 v[92:95], v4 offset:16640
    v_cvt_pk_bf16_f32 v104, v64, v65
    v_cvt_pk_bf16_f32 v105, v66, v67
    v_cvt_pk_bf16_f32 v106, v68, v69
    v_cvt_pk_bf16_f32 v107, v70, v71
    v_exp_f32 v72, v72
    v_exp_f32 v73, v73
    v_mfma_f32_32x32x16_bf16 v[176:191], v[96:99], v[104:107], v[176:191]
    s_cmp_lt_u32 s71, s75
    v_exp_f32 v74, v74
    v_exp_f32 v75, v75
    v_exp_f32 v76, v76
    v_exp_f32 v77, v77
    v_exp_f32 v78, v78
    v_exp_f32 v79, v79
    v_cvt_pk_bf16_f32 v108, v72, v73
    v_cvt_pk_bf16_f32 v109, v74, v75
    v_cvt_pk_bf16_f32 v110, v76, v77
    v_cvt_pk_bf16_f32 v111, v78, v79
    v_add_u32 v2, 16640, v2
    v_add_u32 v3, 16640, v3
    v_add_u32 v4, 16640, v4
    s_cbranch_scc1 L_BLOOP
    s_cmp_lt_u32 s71, 16
    s_cbranch_scc1 L_BAR2
    v_mfma_f32_32x32x16_bf16 v[176:191], v[100:103], v[108:111], v[176:191]
    v_mov_b32 v169, v168
    s_nop 1
    v_permlane32_swap_b32 v168, v169
    v_rcp_f32 v170, v168
    s_waitcnt lgkmcnt(0)
    v_mul_f32 v48, v160, v170
    v_mul_f32 v49, v161, v170
    v_mul_f32 v50, v162, v170
    v_mul_f32 v51, v163, v170
    v_mul_f32 v52, v164, v170
    v_mul_f32 v53, v165, v170
    v_mul_f32 v54, v166, v170
    v_mul_f32 v55, v167, v170
    v_mov_b32 v185, v184
    v_cvt_pk_bf16_f32 v172, v48, v49
    v_cvt_pk_bf16_f32 v173, v50, v51
    v_cvt_pk_bf16_f32 v174, v52, v53
    v_cvt_pk_bf16_f32 v175, v54, v55
    v_permlane32_swap_b32 v184, v185
    v_add_f32 v16, v168, v184
    v_rcp_f32 v186, v184
    v_cmp_nle_f32 vcc, v16, s98
    s_cmp_lg_u32 s70, 0
    s_cbranch_scc1 L_FIN
    s_cbranch_vccnz L_FALLBACK
L_FIN:
    buffer_store_dwordx4 v[172:175], v19, s[24:27], s73 offen sc1
    v_mul_f32 v176, v176, v186
    v_mul_f32 v177, v177, v186
    v_mul_f32 v178, v178, v186
    v_mul_f32 v179, v179, v186
    v_mul_f32 v180, v180, v186
    v_mul_f32 v181, v181, v186
    v_mul_f32 v182, v182, v186
    v_mul_f32 v183, v183, v186
    v_cvt_pk_bf16_f32 v188, v176, v177
    v_cvt_pk_bf16_f32 v189, v178, v179
    v_cvt_pk_bf16_f32 v190, v180, v181
    v_cvt_pk_bf16_f32 v191, v182, v183
    buffer_store_dwordx4 v[188:191], v19, s[24:27], s74 offen sc1
    v_mov_b32 v12, 0
    v_mov_b32 v13, 2
    s_mov_b64 exec, 1
    s_waitcnt vmcnt(0)
    buffer_store_dword v13, v12, s[24:27], s99 offen sc1
    s_mov_b64 exec, -1
    s_barrier
L_REDUCE:
    s_mov_b32 s52, s18
    s_mov_b32 s53, s19
    s_mov_b32 s54, 2097152
    s_mov_b32 s55, 0x00020000
    v_lshlrev_b32 v52, 16, v240
    v_and_b32 v53, 0xffff0000, v240
    v_lshlrev_b32 v54, 16, v241
    v_and_b32 v55, 0xffff0000, v241
    v_lshlrev_b32 v56, 16, v242
    v_and_b32 v57, 0xffff0000, v242
    v_lshlrev_b32 v58, 16, v243
    v_and_b32 v59, 0xffff0000, v243
    s_barrier
    ds_read_b128 v[20:23], v245 offset:0
    ds_read_b128 v[24:27], v245 offset:512
    ds_read_b128 v[28:31], v245 offset:16896
    ds_read_b128 v[32:35], v245 offset:17408
    ds_read_b128 v[36:39], v245 offset:33792
    ds_read_b128 v[40:43], v245 offset:34304
    ds_read_b128 v[44:47], v245 offset:50688
    ds_read_b128 v[48:51], v245 offset:51200
    s_waitcnt lgkmcnt(6)
    v_pk_add_f32 v[52:53], v[52:53], v[20:21]
    v_pk_add_f32 v[54:55], v[54:55], v[22:23]
    v_pk_add_f32 v[56:57], v[56:57], v[24:25]
    v_pk_add_f32 v[58:59], v[58:59], v[26:27]
    s_waitcnt lgkmcnt(4)
    v_pk_add_f32 v[52:53], v[52:53], v[28:29]
    v_pk_add_f32 v[54:55], v[54:55], v[30:31]
    v_pk_add_f32 v[56:57], v[56:57], v[32:33]
    v_pk_add_f32 v[58:59], v[58:59], v[34:35]
    s_waitcnt lgkmcnt(2)
    v_pk_add_f32 v[52:53], v[52:53], v[36:37]
    v_pk_add_f32 v[54:55], v[54:55], v[38:39]
    v_pk_add_f32 v[56:57], v[56:57], v[40:41]
    v_pk_add_f32 v[58:59], v[58:59], v[42:43]
    s_waitcnt lgkmcnt(0)
    v_pk_add_f32 v[52:53], v[52:53], v[44:45]
    v_pk_add_f32 v[54:55], v[54:55], v[46:47]
    v_pk_add_f32 v[56:57], v[56:57], v[48:49]
    v_pk_add_f32 v[58:59], v[58:59], v[50:51]
    v_cvt_pk_bf16_f32 v12, v52, v53
    v_cvt_pk_bf16_f32 v13, v54, v55
    v_cvt_pk_bf16_f32 v14, v56, v57
    v_cvt_pk_bf16_f32 v15, v58, v59
    buffer_store_dwordx4 v[12:15], v244, s[52:55], s84 offen
    s_branch L_EXIT
L_BAR2:
    s_cmp_eq_u32 s71, 2
    s_cbranch_scc1 L_BAR2A
    s_mov_b32 s75, 16
    s_barrier
    s_branch L_BLOOP
L_BAR2A:
    s_mov_b32 s75, 4
    s_waitcnt vmcnt(0)
    s_lshl_b32 s84, s59, 6
    s_lshl_b32 s85, s56, 3
    s_add_u32 s84, s84, s85
    s_lshl_b32 s84, s84, 10
    s_lshl_b32 s85, s60, 7
    s_add_u32 s84, s84, s85
    v_lshrrev_b32 v246, 3, v17
    v_and_b32 v247, 7, v17
    v_lshlrev_b32 v244, 4, v247
    v_lshl_add_u32 v244, v246, 10, v244
    buffer_load_dwordx4 v[240:243], v244, s[28:31], s84 offen
    s_lshr_b32 s85, s56, 2
    s_mul_i32 s85, s85, 8448
    s_and_b32 s86, s56, 3
    s_lshl_b32 s86, s86, 7
    s_add_u32 s85, s85, s86
    v_mul_u32_u24 v245, 1056, v247
    v_lshl_add_u32 v245, v246, 4, v245
    v_add_u32 v245, s85, v245
    v_mov_b32 v7, 18874368
    s_barrier
    s_mov_b64 exec, 1
    buffer_store_dwordx4 v[36:39], v7, s[24:27], s72 offen sc1
    s_mov_b64 exec, -1
    s_branch L_BLOOP
L_FALLBACK:
    s_mov_b32 s70, 1
    s_mov_b32 s71, 0
    v_mov_b32 v2, v19
    v_mov_b32 v5, 0xff800000
    v_mov_b32 v6, 0xff800000
L_MAXLOOP:
    ds_read_b128 v[80:83], v2
    v_add_u32 v2, 2080, v2
    s_waitcnt lgkmcnt(0)
    v_mfma_f32_32x32x16_bf16 v[48:63], v[80:83], v[40:43], 0
    v_mfma_f32_32x32x16_bf16 v[64:79], v[80:83], v[44:47], 0
    s_nop 15
    v_max3_f32 v5, v5, v48, v49
    v_max3_f32 v5, v5, v50, v51
    v_max3_f32 v5, v5, v52, v53
    v_max3_f32 v5, v5, v54, v55
    v_max3_f32 v5, v5, v56, v57
    v_max3_f32 v5, v5, v58, v59
    v_max3_f32 v5, v5, v60, v61
    v_max3_f32 v5, v5, v62, v63
    v_max3_f32 v6, v6, v64, v65
    v_max3_f32 v6, v6, v66, v67
    v_max3_f32 v6, v6, v68, v69
    v_max3_f32 v6, v6, v70, v71
    v_max3_f32 v6, v6, v72, v73
    v_max3_f32 v6, v6, v74, v75
    v_max3_f32 v6, v6, v76, v77
    v_max3_f32 v6, v6, v78, v79
    s_add_u32 s71, s71, 1
    s_cmp_lt_u32 s71, 64
    s_cbranch_scc1 L_MAXLOOP
    s_branch L_SETC
L_EXIT:
L_END:
    s_endpgm
L_CODE_END:
.section .rodata,"a"
.p2align 6
.amdhsa_kernel parallel_sum__softmax_full_mha__glu_gated_swiglu__prompt_kernel
  .amdhsa_next_free_vgpr 256
  .amdhsa_next_free_sgpr 102
  .amdhsa_accum_offset 256
  .amdhsa_group_segment_fixed_size 0
  .amdhsa_kernarg_size 80
  .amdhsa_user_sgpr_count 2
  .amdhsa_user_sgpr_kernarg_segment_ptr 1
  .amdhsa_system_sgpr_workgroup_id_x 1
.end_amdhsa_kernel
```
